```python
import torch

def _softmax(x, axis=-1):
    return torch.softmax(x, dim=axis)
def _gelu(x):
    return torch.nn.functional.gelu(x, approximate="tanh")
def _silu(x):
    return torch.nn.functional.silu(x)
def _sigmoid(x):
    return torch.sigmoid(x)
def _layernorm(x, axis=-1, eps=1e-5):
    m = x.mean(dim=axis, keepdim=True)
    v = x.var(dim=axis, keepdim=True, unbiased=False)
    return (x - m) / torch.sqrt(v + eps)
def _scatter_add(tgt, idx, src, axis=0):
    return tgt.clone().index_add_(axis, idx, src)
def _segment_sum(src, seg, n):
    out = torch.zeros((n,) + src.shape[1:], dtype=src.dtype)
    return out.index_add_(0, seg, src)
def _pad(x, pw):
    flat = tuple(v for pair in reversed(pw) for v in pair)
    return torch.nn.functional.pad(x, flat)

kernel_name = 'gated_mix__softmax_full_mha__dense_activation_mish__prompt'

def setup_inputs():

    _w = (lambda a: (lambda t: t.to(torch.bfloat16) if t.is_floating_point() else t)(torch.as_tensor(a)))
    def _A_setup():
        B, S, D = 1, 2048, 512
        return {
            "x": _w((lambda *s: torch.randn(*s, dtype=torch.bfloat16) * 0.05)(B, S, D)),
            "wqkv": _w((lambda *s: torch.randn(*s, dtype=torch.bfloat16) * 0.8)(D, 3 * D)),
            "wo": _w((lambda *s: torch.randn(*s, dtype=torch.bfloat16) * 0.05)(D, D)),
        }
    _A_in = _A_setup()

    def _B_setup():
        B, S, D, F = 1, 2048, 512, 1376
        return {
            "x": _w((lambda *s: torch.randn(*s, dtype=torch.bfloat16) * 0.05)(B, S, D)),
            "w1": _w((lambda *s: torch.randn(*s, dtype=torch.bfloat16) * 12.8)(D, F) * (D ** -0.5)),
            "b1": _w((lambda *s: torch.randn(*s, dtype=torch.bfloat16) * 0.2)(F)),
            "w2": _w((lambda *s: torch.randn(*s, dtype=torch.bfloat16) * 0.1)(F, D) * (F ** -0.5)),
        }
    _B_in = _B_setup()

    return {
        "A_x": _A_in["x"],
        "A_wqkv": _A_in["wqkv"],
        "A_wo": _A_in["wo"],
        "B_x": _B_in["x"],
        "B_w1": _B_in["w1"],
        "B_b1": _B_in["b1"],
        "B_w2": _B_in["w2"],
        "gate_w": _w((lambda *s: torch.randn(*s, dtype=torch.bfloat16) * 0.05)(512) * 16.0),
    }

def reference(A_x, A_wqkv, A_wo, B_x, B_w1, B_b1, B_w2, gate_w):
    def _A_ref(x, wqkv, wo):
        B, S, D = x.shape
        H = 32; Dh = D // H
        qkv = (lambda x, *d: x.permute(*d))((x @ wqkv).reshape(B, S, 3, H, Dh), 2, 0, 3, 1, 4)
        q, k, v = qkv[0], qkv[1], qkv[2]
        scale = Dh ** -0.5
        scores = torch.einsum("bhqd,bhkd->bhqk", q, k) * scale
        p = _softmax(scores, axis=-1)
        o = torch.einsum("bhqk,bhkd->bhqd", p, v)
        return (lambda x, *d: x.permute(*d))(o, 0, 2, 1, 3).reshape(B, S, D) @ wo

    def _B_ref(x, w1, b1, w2):
        h = torch.einsum("bsd,df->bsf", x, w1) + b1
        sp = torch.log1p(torch.exp(-torch.abs(h))) + torch.where(h > 0, h, torch.zeros_like(h))
        act = h * torch.tanh(sp)
        return torch.einsum("bsf,fd->bsd", act, w2)

    x = A_x
    g = _sigmoid((x * gate_w).sum(-1, keepdims=True))
    a = _A_ref(x, A_wqkv, A_wo)
    b = _B_ref(x, B_w1, B_b1, B_w2)
    return g * a + (1 - g) * b
```

```asm
; @launch kernel=proj_kernel grid=(256,1,1) block=(768,1,1) lds=122880
; @launch kernel=attn_kernel grid=(256,1,1) block=(768,1,1) lds=147712
; @launch kernel=out_kernel grid=(256,1,1) block=(256,1,1) lds=65536
.amdgcn_target "amdgcn-amd-amdhsa--gfx950"
.text
.globl proj_kernel
.p2align 8
.type proj_kernel,@function
proj_kernel:
    s_cmp_ge_u32 s2, 256
    s_cbranch_scc1 K1_END
    s_load_dwordx4 s[4:7], s[0:1], 0
    s_load_dwordx4 s[8:11], s[0:1], 32
    s_load_dwordx2 s[12:13], s[0:1], 80
    s_load_dwordx4 s[60:63], s[0:1], 48
    s_load_dwordx2 s[64:65], s[0:1], 16
    s_and_b32 s44, s2, 7
    s_lshr_b32 s45, s2, 3
    s_and_b32 s46, s44, 1
    s_lshl_b32 s46, s46, 3
    s_and_b32 s47, s45, 7
    s_add_u32 s36, s46, s47
    s_lshr_b32 s46, s44, 1
    s_lshl_b32 s46, s46, 2
    s_lshr_b32 s47, s45, 3
    s_add_u32 s37, s46, s47
    s_mul_i32 s46, s37, 96
    s_lshl_b32 s47, s37, 6
    s_add_u32 s47, s47, 352
    s_cmp_lt_u32 s37, 11
    s_cselect_b32 s39, s46, s47
    v_and_b32 v1, 63, v0
    v_lshrrev_b32 v2, 6, v0
    s_nop 0
    v_readfirstlane_b32 s38, v2
    s_waitcnt lgkmcnt(0)
    s_mov_b32 s16, s4
    s_and_b32 s17, s5, 0xffff
    s_mov_b32 s18, 2097152
    s_mov_b32 s19, 0x00020000
    s_cmp_lt_u32 s38, 8
    s_cbranch_scc1 K1_COMP
    s_sub_u32 s42, s38, 8
    v_lshrrev_b32 v2, 3, v1
    v_and_b32 v3, 7, v1
    v_lshrrev_b32 v4, 1, v2
    v_xor_b32 v5, v3, v4
    s_lshl_b32 s44, s36, 7
    s_lshl_b32 s45, s42, 5
    s_add_u32 s44, s44, s45
    v_add_u32 v2, s44, v2
    v_lshlrev_b32 v2, 10, v2
    v_lshl_add_u32 v6, v5, 4, v2
    v_xor_b32 v5, 4, v5
    v_lshl_add_u32 v13, v5, 4, v2
    s_lshl_b32 s43, s42, 12
    s_mul_i32 s50, s42, 3072
    s_lshr_b32 s44, s2, 3
    s_lshr_b32 s45, s44, 3
    s_and_b32 s44, s44, 7
    s_lshl_b32 s45, s45, 1
    s_add_u32 s44, s44, s45
    s_and_b32 s51, s44, 7
    s_lshl_b32 s68, s51, 7
    s_add_u32 m0, s43, 0
    s_add_u32 s44, s68, 0
    buffer_load_dwordx4 v6, s[16:19], s44 offen lds
    s_add_u32 m0, s43, 1024
    s_add_u32 s44, s68, 8192
    buffer_load_dwordx4 v13, s[16:19], s44 offen lds
    s_add_u32 m0, s43, 2048
    s_add_u32 s44, s68, 16384
    buffer_load_dwordx4 v6, s[16:19], s44 offen lds
    s_add_u32 m0, s43, 3072
    s_add_u32 s44, s68, 24576
    buffer_load_dwordx4 v13, s[16:19], s44 offen lds
    s_mov_b32 s20, s6
    s_and_b32 s21, s7, 0xffff
    s_mov_b32 s22, 1572864
    s_mov_b32 s23, 0x00020000
    s_mov_b32 s24, s8
    s_and_b32 s25, s9, 0xffff
    s_mov_b32 s26, 1409024
    s_mov_b32 s27, 0x00020000
    v_add_u32 v2, 0, v1
    v_mul_u32_u24 v3, 43691, v2
    v_lshrrev_b32 v3, 19, v3
    v_mul_u32_u24 v4, 12, v3
    v_sub_u32 v4, v2, v4
    s_lshl_b32 s44, s42, 4
    v_add_u32 v3, s44, v3
    v_mul_u32_u24 v5, 3072, v3
    v_lshrrev_b32 v2, 2, v4
    v_lshl_add_u32 v5, v2, 10, v5
    v_and_b32 v2, 3, v4
    v_lshl_add_u32 v5, v2, 4, v5
    s_lshl_b32 s44, s37, 6
    v_add_u32 v7, s44, v5
    v_mul_u32_u24 v5, 2752, v3
    v_lshl_add_u32 v5, v4, 4, v5
    s_lshl_b32 s44, s39, 1
    v_add_u32 v10, s44, v5
    v_add_u32 v2, 64, v1
    v_mul_u32_u24 v3, 43691, v2
    v_lshrrev_b32 v3, 19, v3
    v_mul_u32_u24 v4, 12, v3
    v_sub_u32 v4, v2, v4
    s_lshl_b32 s44, s42, 4
    v_add_u32 v3, s44, v3
    v_mul_u32_u24 v5, 3072, v3
    v_lshrrev_b32 v2, 2, v4
    v_lshl_add_u32 v5, v2, 10, v5
    v_and_b32 v2, 3, v4
    v_lshl_add_u32 v5, v2, 4, v5
    s_lshl_b32 s44, s37, 6
    v_add_u32 v8, s44, v5
    v_mul_u32_u24 v5, 2752, v3
    v_lshl_add_u32 v5, v4, 4, v5
    s_lshl_b32 s44, s39, 1
    v_add_u32 v11, s44, v5
    v_add_u32 v2, 128, v1
    v_mul_u32_u24 v3, 43691, v2
    v_lshrrev_b32 v3, 19, v3
    v_mul_u32_u24 v4, 12, v3
    v_sub_u32 v4, v2, v4
    s_lshl_b32 s44, s42, 4
    v_add_u32 v3, s44, v3
    v_mul_u32_u24 v5, 3072, v3
    v_lshrrev_b32 v2, 2, v4
    v_lshl_add_u32 v5, v2, 10, v5
    v_and_b32 v2, 3, v4
    v_lshl_add_u32 v5, v2, 4, v5
    s_lshl_b32 s44, s37, 6
    v_add_u32 v9, s44, v5
    v_mul_u32_u24 v5, 2752, v3
    v_lshl_add_u32 v5, v4, 4, v5
    s_lshl_b32 s44, s39, 1
    v_add_u32 v12, s44, v5
    s_add_u32 s44, s51, 0
    s_and_b32 s44, s44, 7
    s_lshl_b32 s68, s44, 7
    s_mul_i32 s69, s44, 196608
    s_mul_i32 s45, s44, 176128
    s_add_u32 m0, s50, 16384
    s_nop 0
    buffer_load_dwordx4 v7, s[20:23], s69 offen lds
    s_add_u32 m0, s50, 17408
    s_nop 0
    buffer_load_dwordx4 v8, s[20:23], s69 offen lds
    s_add_u32 m0, s50, 18432
    s_nop 0
    buffer_load_dwordx4 v9, s[20:23], s69 offen lds
    s_add_u32 m0, s50, 28672
    s_nop 0
    buffer_load_dwordx4 v10, s[24:27], s45 offen lds
    s_add_u32 m0, s50, 29696
    s_nop 0
    buffer_load_dwordx4 v11, s[24:27], s45 offen lds
    s_add_u32 m0, s50, 30720
    s_nop 0
    buffer_load_dwordx4 v12, s[24:27], s45 offen lds
    s_add_u32 s44, s51, 1
    s_and_b32 s44, s44, 7
    s_lshl_b32 s68, s44, 7
    s_mul_i32 s69, s44, 196608
    s_mul_i32 s45, s44, 176128
    s_add_u32 m0, s43, 40960
    s_add_u32 s44, s68, 0
    buffer_load_dwordx4 v6, s[16:19], s44 offen lds
    s_add_u32 m0, s43, 41984
    s_add_u32 s44, s68, 8192
    buffer_load_dwordx4 v13, s[16:19], s44 offen lds
    s_add_u32 m0, s43, 43008
    s_add_u32 s44, s68, 16384
    buffer_load_dwordx4 v6, s[16:19], s44 offen lds
    s_add_u32 m0, s43, 44032
    s_add_u32 s44, s68, 24576
    buffer_load_dwordx4 v13, s[16:19], s44 offen lds
    s_add_u32 m0, s50, 57344
    s_nop 0
    buffer_load_dwordx4 v7, s[20:23], s69 offen lds
    s_add_u32 m0, s50, 58368
    s_nop 0
    buffer_load_dwordx4 v8, s[20:23], s69 offen lds
    s_add_u32 m0, s50, 59392
    s_nop 0
    buffer_load_dwordx4 v9, s[20:23], s69 offen lds
    s_add_u32 m0, s50, 69632
    s_nop 0
    buffer_load_dwordx4 v10, s[24:27], s45 offen lds
    s_add_u32 m0, s50, 70656
    s_nop 0
    buffer_load_dwordx4 v11, s[24:27], s45 offen lds
    s_add_u32 m0, s50, 71680
    s_nop 0
    buffer_load_dwordx4 v12, s[24:27], s45 offen lds
    s_waitcnt vmcnt(10)
    s_barrier
    s_add_u32 s44, s51, 2
    s_and_b32 s44, s44, 7
    s_lshl_b32 s68, s44, 7
    s_mul_i32 s69, s44, 196608
    s_mul_i32 s45, s44, 176128
    s_add_u32 m0, s43, 81920
    s_add_u32 s44, s68, 0
    buffer_load_dwordx4 v6, s[16:19], s44 offen lds
    s_add_u32 m0, s43, 82944
    s_add_u32 s44, s68, 8192
    buffer_load_dwordx4 v13, s[16:19], s44 offen lds
    s_add_u32 m0, s43, 83968
    s_add_u32 s44, s68, 16384
    buffer_load_dwordx4 v6, s[16:19], s44 offen lds
    s_add_u32 m0, s43, 84992
    s_add_u32 s44, s68, 24576
    buffer_load_dwordx4 v13, s[16:19], s44 offen lds
    s_add_u32 m0, s50, 98304
    s_nop 0
    buffer_load_dwordx4 v7, s[20:23], s69 offen lds
    s_add_u32 m0, s50, 99328
    s_nop 0
    buffer_load_dwordx4 v8, s[20:23], s69 offen lds
    s_add_u32 m0, s50, 100352
    s_nop 0
    buffer_load_dwordx4 v9, s[20:23], s69 offen lds
    s_add_u32 m0, s50, 110592
    s_nop 0
    buffer_load_dwordx4 v10, s[24:27], s45 offen lds
    s_add_u32 m0, s50, 111616
    s_nop 0
    buffer_load_dwordx4 v11, s[24:27], s45 offen lds
    s_add_u32 m0, s50, 112640
    s_nop 0
    buffer_load_dwordx4 v12, s[24:27], s45 offen lds
    s_waitcnt vmcnt(10)
    s_barrier
    s_add_u32 s44, s51, 3
    s_and_b32 s44, s44, 7
    s_lshl_b32 s68, s44, 7
    s_mul_i32 s69, s44, 196608
    s_mul_i32 s45, s44, 176128
    s_add_u32 m0, s43, 0
    s_add_u32 s44, s68, 0
    buffer_load_dwordx4 v6, s[16:19], s44 offen lds
    s_add_u32 m0, s43, 1024
    s_add_u32 s44, s68, 8192
    buffer_load_dwordx4 v13, s[16:19], s44 offen lds
    s_add_u32 m0, s43, 2048
    s_add_u32 s44, s68, 16384
    buffer_load_dwordx4 v6, s[16:19], s44 offen lds
    s_add_u32 m0, s43, 3072
    s_add_u32 s44, s68, 24576
    buffer_load_dwordx4 v13, s[16:19], s44 offen lds
    s_add_u32 m0, s50, 16384
    s_nop 0
    buffer_load_dwordx4 v7, s[20:23], s69 offen lds
    s_add_u32 m0, s50, 17408
    s_nop 0
    buffer_load_dwordx4 v8, s[20:23], s69 offen lds
    s_add_u32 m0, s50, 18432
    s_nop 0
    buffer_load_dwordx4 v9, s[20:23], s69 offen lds
    s_add_u32 m0, s50, 28672
    s_nop 0
    buffer_load_dwordx4 v10, s[24:27], s45 offen lds
    s_add_u32 m0, s50, 29696
    s_nop 0
    buffer_load_dwordx4 v11, s[24:27], s45 offen lds
    s_add_u32 m0, s50, 30720
    s_nop 0
    buffer_load_dwordx4 v12, s[24:27], s45 offen lds
    s_waitcnt vmcnt(10)
    s_barrier
    s_add_u32 s44, s51, 4
    s_and_b32 s44, s44, 7
    s_lshl_b32 s68, s44, 7
    s_mul_i32 s69, s44, 196608
    s_mul_i32 s45, s44, 176128
    s_add_u32 m0, s43, 40960
    s_add_u32 s44, s68, 0
    buffer_load_dwordx4 v6, s[16:19], s44 offen lds
    s_add_u32 m0, s43, 41984
    s_add_u32 s44, s68, 8192
    buffer_load_dwordx4 v13, s[16:19], s44 offen lds
    s_add_u32 m0, s43, 43008
    s_add_u32 s44, s68, 16384
    buffer_load_dwordx4 v6, s[16:19], s44 offen lds
    s_add_u32 m0, s43, 44032
    s_add_u32 s44, s68, 24576
    buffer_load_dwordx4 v13, s[16:19], s44 offen lds
    s_add_u32 m0, s50, 57344
    s_nop 0
    buffer_load_dwordx4 v7, s[20:23], s69 offen lds
    s_add_u32 m0, s50, 58368
    s_nop 0
    buffer_load_dwordx4 v8, s[20:23], s69 offen lds
    s_add_u32 m0, s50, 59392
    s_nop 0
    buffer_load_dwordx4 v9, s[20:23], s69 offen lds
    s_add_u32 m0, s50, 69632
    s_nop 0
    buffer_load_dwordx4 v10, s[24:27], s45 offen lds
    s_add_u32 m0, s50, 70656
    s_nop 0
    buffer_load_dwordx4 v11, s[24:27], s45 offen lds
    s_add_u32 m0, s50, 71680
    s_nop 0
    buffer_load_dwordx4 v12, s[24:27], s45 offen lds
    s_waitcnt vmcnt(10)
    s_barrier
    s_add_u32 s44, s51, 5
    s_and_b32 s44, s44, 7
    s_lshl_b32 s68, s44, 7
    s_mul_i32 s69, s44, 196608
    s_mul_i32 s45, s44, 176128
    s_add_u32 m0, s43, 81920
    s_add_u32 s44, s68, 0
    buffer_load_dwordx4 v6, s[16:19], s44 offen lds
    s_add_u32 m0, s43, 82944
    s_add_u32 s44, s68, 8192
    buffer_load_dwordx4 v13, s[16:19], s44 offen lds
    s_add_u32 m0, s43, 83968
    s_add_u32 s44, s68, 16384
    buffer_load_dwordx4 v6, s[16:19], s44 offen lds
    s_add_u32 m0, s43, 84992
    s_add_u32 s44, s68, 24576
    buffer_load_dwordx4 v13, s[16:19], s44 offen lds
    s_add_u32 m0, s50, 98304
    s_nop 0
    buffer_load_dwordx4 v7, s[20:23], s69 offen lds
    s_add_u32 m0, s50, 99328
    s_nop 0
    buffer_load_dwordx4 v8, s[20:23], s69 offen lds
    s_add_u32 m0, s50, 100352
    s_nop 0
    buffer_load_dwordx4 v9, s[20:23], s69 offen lds
    s_add_u32 m0, s50, 110592
    s_nop 0
    buffer_load_dwordx4 v10, s[24:27], s45 offen lds
    s_add_u32 m0, s50, 111616
    s_nop 0
    buffer_load_dwordx4 v11, s[24:27], s45 offen lds
    s_add_u32 m0, s50, 112640
    s_nop 0
    buffer_load_dwordx4 v12, s[24:27], s45 offen lds
    s_waitcnt vmcnt(10)
    s_barrier
    s_add_u32 s44, s51, 6
    s_and_b32 s44, s44, 7
    s_lshl_b32 s68, s44, 7
    s_mul_i32 s69, s44, 196608
    s_mul_i32 s45, s44, 176128
    s_add_u32 m0, s43, 0
    s_add_u32 s44, s68, 0
    buffer_load_dwordx4 v6, s[16:19], s44 offen lds
    s_add_u32 m0, s43, 1024
    s_add_u32 s44, s68, 8192
    buffer_load_dwordx4 v13, s[16:19], s44 offen lds
    s_add_u32 m0, s43, 2048
    s_add_u32 s44, s68, 16384
    buffer_load_dwordx4 v6, s[16:19], s44 offen lds
    s_add_u32 m0, s43, 3072
    s_add_u32 s44, s68, 24576
    buffer_load_dwordx4 v13, s[16:19], s44 offen lds
    s_add_u32 m0, s50, 16384
    s_nop 0
    buffer_load_dwordx4 v7, s[20:23], s69 offen lds
    s_add_u32 m0, s50, 17408
    s_nop 0
    buffer_load_dwordx4 v8, s[20:23], s69 offen lds
    s_add_u32 m0, s50, 18432
    s_nop 0
    buffer_load_dwordx4 v9, s[20:23], s69 offen lds
    s_add_u32 m0, s50, 28672
    s_nop 0
    buffer_load_dwordx4 v10, s[24:27], s45 offen lds
    s_add_u32 m0, s50, 29696
    s_nop 0
    buffer_load_dwordx4 v11, s[24:27], s45 offen lds
    s_add_u32 m0, s50, 30720
    s_nop 0
    buffer_load_dwordx4 v12, s[24:27], s45 offen lds
    s_waitcnt vmcnt(10)
    s_barrier
    s_add_u32 s44, s51, 7
    s_and_b32 s44, s44, 7
    s_lshl_b32 s68, s44, 7
    s_mul_i32 s69, s44, 196608
    s_mul_i32 s45, s44, 176128
    s_add_u32 m0, s43, 40960
    s_add_u32 s44, s68, 0
    buffer_load_dwordx4 v6, s[16:19], s44 offen lds
    s_add_u32 m0, s43, 41984
    s_add_u32 s44, s68, 8192
    buffer_load_dwordx4 v13, s[16:19], s44 offen lds
    s_add_u32 m0, s43, 43008
    s_add_u32 s44, s68, 16384
    buffer_load_dwordx4 v6, s[16:19], s44 offen lds
    s_add_u32 m0, s43, 44032
    s_add_u32 s44, s68, 24576
    buffer_load_dwordx4 v13, s[16:19], s44 offen lds
    s_add_u32 m0, s50, 57344
    s_nop 0
    buffer_load_dwordx4 v7, s[20:23], s69 offen lds
    s_add_u32 m0, s50, 58368
    s_nop 0
    buffer_load_dwordx4 v8, s[20:23], s69 offen lds
    s_add_u32 m0, s50, 59392
    s_nop 0
    buffer_load_dwordx4 v9, s[20:23], s69 offen lds
    s_add_u32 m0, s50, 69632
    s_nop 0
    buffer_load_dwordx4 v10, s[24:27], s45 offen lds
    s_add_u32 m0, s50, 70656
    s_nop 0
    buffer_load_dwordx4 v11, s[24:27], s45 offen lds
    s_add_u32 m0, s50, 71680
    s_nop 0
    buffer_load_dwordx4 v12, s[24:27], s45 offen lds
    s_waitcnt vmcnt(10)
    s_barrier
    s_waitcnt vmcnt(0)
    s_barrier
K1_END:
    s_endpgm
K1_COMP:
    s_mov_b32 s28, s10
    s_and_b32 s29, s11, 0xffff
    s_mov_b32 s30, 2752
    s_mov_b32 s31, 0x00020000
    s_mov_b32 s32, s12
    s_and_b32 s33, s13, 0xffff
    s_mov_b32 s34, 268435456
    s_mov_b32 s35, 0x00020000
    s_mov_b32 s52, s60
    s_and_b32 s53, s61, 0xffff
    s_mov_b32 s54, 1409024
    s_mov_b32 s55, 0x00020000
    s_mov_b32 s56, s62
    s_and_b32 s57, s63, 0xffff
    s_mov_b32 s58, 1024
    s_mov_b32 s59, 0x00020000
    s_mov_b32 s64, s64
    s_and_b32 s65, s65, 0xffff
    s_mov_b32 s66, 524288
    s_mov_b32 s67, 0x00020000
    v_lshrrev_b32 v2, 5, v1
    v_lshlrev_b32 v2, 12, v2
    v_and_b32 v3, 31, v1
    v_lshl_add_u32 v2, v3, 1, v2
    v_lshlrev_b32 v4, 4, v1
    s_lshl_b32 s44, s36, 7
    s_lshl_b32 s45, s37, 3
    s_add_u32 s44, s44, s45
    s_add_u32 s48, s44, s38
    s_lshl_b32 s45, s48, 10
    buffer_load_dwordx4 v[32:35], v4, s[16:19], s45 offen
    buffer_load_dwordx4 v[36:39], v4, s[56:59], 0 offen
    s_lshl_b32 s44, s2, 3
    s_add_u32 s44, s44, s38
    s_cmp_ge_u32 s44, 1888
    s_cbranch_scc1 K1_TRDONE
    s_cmp_ge_u32 s44, 1376
    s_cbranch_scc1 K1_TRWO
    s_lshr_b32 s45, s44, 4
    s_and_b32 s46, s44, 15
    s_lshl_b32 s45, s45, 14
    s_lshl_b32 s46, s46, 6
    s_add_u32 s45, s45, s46
    s_add_u32 s46, s45, 0
    buffer_load_ushort v16, v2, s[52:55], s46 offen
    s_add_u32 s46, s45, 1024
    buffer_load_ushort v17, v2, s[52:55], s46 offen
    s_add_u32 s46, s45, 2048
    buffer_load_ushort v18, v2, s[52:55], s46 offen
    s_add_u32 s46, s45, 3072
    buffer_load_ushort v19, v2, s[52:55], s46 offen
    s_add_u32 s46, s45, 8192
    buffer_load_ushort v20, v2, s[52:55], s46 offen
    s_add_u32 s46, s45, 9216
    buffer_load_ushort v21, v2, s[52:55], s46 offen
    s_add_u32 s46, s45, 10240
    buffer_load_ushort v22, v2, s[52:55], s46 offen
    s_add_u32 s46, s45, 11264
    buffer_load_ushort v23, v2, s[52:55], s46 offen
    s_waitcnt vmcnt(0)
    v_lshl_or_b32 v24, v17, 16, v16
    v_lshl_or_b32 v25, v19, 16, v18
    v_lshl_or_b32 v26, v21, 16, v20
    v_lshl_or_b32 v27, v23, 16, v22
    s_lshl_b32 s46, s44, 10
    s_add_u32 s46, s46, 20971520
    buffer_store_dwordx4 v[24:27], v4, s[32:35], s46 offen sc1
    s_branch K1_TRDONE
K1_TRWO:
    s_sub_u32 s44, s44, 1376
    s_lshr_b32 s45, s44, 4
    s_and_b32 s46, s44, 15
    s_lshl_b32 s45, s45, 14
    s_lshl_b32 s46, s46, 6
    s_add_u32 s45, s45, s46
    s_add_u32 s46, s45, 0
    buffer_load_ushort v16, v2, s[64:67], s46 offen
    s_add_u32 s46, s45, 1024
    buffer_load_ushort v17, v2, s[64:67], s46 offen
    s_add_u32 s46, s45, 2048
    buffer_load_ushort v18, v2, s[64:67], s46 offen
    s_add_u32 s46, s45, 3072
    buffer_load_ushort v19, v2, s[64:67], s46 offen
    s_add_u32 s46, s45, 8192
    buffer_load_ushort v20, v2, s[64:67], s46 offen
    s_add_u32 s46, s45, 9216
    buffer_load_ushort v21, v2, s[64:67], s46 offen
    s_add_u32 s46, s45, 10240
    buffer_load_ushort v22, v2, s[64:67], s46 offen
    s_add_u32 s46, s45, 11264
    buffer_load_ushort v23, v2, s[64:67], s46 offen
    s_waitcnt vmcnt(0)
    v_lshl_or_b32 v24, v17, 16, v16
    v_lshl_or_b32 v25, v19, 16, v18
    v_lshl_or_b32 v26, v21, 16, v20
    v_lshl_or_b32 v27, v23, 16, v22
    s_lshl_b32 s46, s44, 10
    s_add_u32 s46, s46, 23068672
    buffer_store_dwordx4 v[24:27], v4, s[32:35], s46 offen sc1
K1_TRDONE:
    s_waitcnt vmcnt(0)
    v_lshlrev_b32 v40, 16, v36
    v_and_b32 v41, 0xffff0000, v36
    v_lshlrev_b32 v48, 16, v32
    v_and_b32 v49, 0xffff0000, v32
    v_lshlrev_b32 v42, 16, v37
    v_and_b32 v43, 0xffff0000, v37
    v_lshlrev_b32 v50, 16, v33
    v_and_b32 v51, 0xffff0000, v33
    v_lshlrev_b32 v44, 16, v38
    v_and_b32 v45, 0xffff0000, v38
    v_lshlrev_b32 v52, 16, v34
    v_and_b32 v53, 0xffff0000, v34
    v_lshlrev_b32 v46, 16, v39
    v_and_b32 v47, 0xffff0000, v39
    v_lshlrev_b32 v54, 16, v35
    v_and_b32 v55, 0xffff0000, v35
    v_mul_f32 v56, v40, v48
    v_fma_f32 v56, v41, v49, v56
    v_fma_f32 v56, v42, v50, v56
    v_fma_f32 v56, v43, v51, v56
    v_fma_f32 v56, v44, v52, v56
    v_fma_f32 v56, v45, v53, v56
    v_fma_f32 v56, v46, v54, v56
    v_fma_f32 v56, v47, v55, v56
    ds_swizzle_b32 v57, v56 offset:1055
    s_waitcnt lgkmcnt(0)
    v_add_f32 v56, v56, v57
    ds_swizzle_b32 v57, v56 offset:2079
    s_waitcnt lgkmcnt(0)
    v_add_f32 v56, v56, v57
    ds_swizzle_b32 v57, v56 offset:4127
    s_waitcnt lgkmcnt(0)
    v_add_f32 v56, v56, v57
    ds_swizzle_b32 v57, v56 offset:8223
    s_waitcnt lgkmcnt(0)
    v_add_f32 v56, v56, v57
    ds_swizzle_b32 v57, v56 offset:16415
    s_waitcnt lgkmcnt(0)
    v_add_f32 v56, v56, v57
    v_mov_b32 v57, v56
    s_nop 1
    v_permlane32_swap_b32 v56, v57
    v_add_f32 v56, v56, v57
    v_mul_f32 v56, 0xbfb8aa3b, v56
    v_exp_f32 v56, v56
    s_nop 0
    v_add_f32 v56, 1.0, v56
    v_rcp_f32 v56, v56
    s_lshl_b32 s45, s48, 2
    s_add_u32 s45, s45, 14680064
    v_mov_b32 v57, 0
    s_mov_b64 exec, 1
    buffer_store_dword v56, v57, s[32:35], s45 offen
    s_mov_b64 exec, -1
    s_lshr_b32 s40, s38, 1
    s_lshr_b32 s44, s38, 2
    s_xor_b32 s44, s44, s38
    s_and_b32 s41, s44, 1
    v_and_b32 v2, 31, v1
    v_lshrrev_b32 v3, 5, v1
    v_lshrrev_b32 v4, 1, v2
    v_and_b32 v4, 7, v4
    s_lshl_b32 s44, s40, 5
    v_add_u32 v2, s44, v2
    v_lshlrev_b32 v2, 7, v2
    v_add_u32 v5, 0, v3
    v_xor_b32 v5, v5, v4
    v_lshl_add_u32 v14, v5, 4, v2
    v_add_u32 v5, 2, v3
    v_xor_b32 v5, v5, v4
    v_lshl_add_u32 v15, v5, 4, v2
    v_add_u32 v5, 4, v3
    v_xor_b32 v5, v5, v4
    v_lshl_add_u32 v16, v5, 4, v2
    v_add_u32 v5, 6, v3
    v_xor_b32 v5, v5, v4
    v_lshl_add_u32 v17, v5, 4, v2
    v_lshrrev_b32 v2, 5, v1
    v_lshlrev_b32 v2, 3, v2
    v_bfe_u32 v3, v1, 2, 2
    v_add_u32 v2, v2, v3
    v_mul_u32_u24 v2, 192, v2
    v_bfe_u32 v3, v1, 4, 1
    v_lshl_add_u32 v2, v3, 5, v2
    v_and_b32 v3, 3, v1
    v_lshl_add_u32 v18, v3, 3, v2
    s_cmp_eq_u32 s41, 1
    s_cbranch_scc1 K1_NH1
    v_lshrrev_b32 v2, 5, v1
    v_lshlrev_b32 v2, 3, v2
    s_add_u32 s47, s39, 0
    s_lshl_b32 s49, s47, 1
    buffer_load_dwordx2 v[128:129], v2, s[28:31], s49 offen offset:0
    buffer_load_dwordx2 v[130:131], v2, s[28:31], s49 offen offset:16
    buffer_load_dwordx2 v[132:133], v2, s[28:31], s49 offen offset:32
    buffer_load_dwordx2 v[134:135], v2, s[28:31], s49 offen offset:48
    s_barrier
    v_add_u32 v19, 0, v14
    v_add_u32 v20, 0, v15
    v_add_u32 v21, 0, v16
    v_add_u32 v22, 0, v17
    v_add_u32 v23, 16384, v18
    ds_read_b128 v[24:27], v19
    ds_read_b64_tr_b16 v[32:33], v23 offset:0
    ds_read_b64_tr_b16 v[34:35], v23 offset:768
    ds_read_b64_tr_b16 v[36:37], v23 offset:64
    ds_read_b64_tr_b16 v[38:39], v23 offset:832
    ds_read_b64_tr_b16 v[40:41], v23 offset:12288
    ds_read_b64_tr_b16 v[42:43], v23 offset:13056
    s_waitcnt lgkmcnt(0)
    ds_read_b128 v[28:31], v20
    ds_read_b64_tr_b16 v[44:45], v23 offset:3072
    ds_read_b64_tr_b16 v[46:47], v23 offset:3840
    ds_read_b64_tr_b16 v[48:49], v23 offset:3136
    ds_read_b64_tr_b16 v[50:51], v23 offset:3904
    ds_read_b64_tr_b16 v[52:53], v23 offset:15360
    ds_read_b64_tr_b16 v[54:55], v23 offset:16128
    v_mfma_f32_32x32x16_bf16 v[64:79], v[32:35], v[24:27], 0
    v_mfma_f32_32x32x16_bf16 v[80:95], v[36:39], v[24:27], 0
    v_mfma_f32_32x32x16_bf16 v[96:111], v[40:43], v[24:27], 0
    s_waitcnt lgkmcnt(0)
    ds_read_b128 v[24:27], v21
    ds_read_b64_tr_b16 v[32:33], v23 offset:6144
    ds_read_b64_tr_b16 v[34:35], v23 offset:6912
    ds_read_b64_tr_b16 v[36:37], v23 offset:6208
    ds_read_b64_tr_b16 v[38:39], v23 offset:6976
    ds_read_b64_tr_b16 v[40:41], v23 offset:18432
    ds_read_b64_tr_b16 v[42:43], v23 offset:19200
    v_mfma_f32_32x32x16_bf16 v[64:79], v[44:47], v[28:31], v[64:79]
    v_mfma_f32_32x32x16_bf16 v[80:95], v[48:51], v[28:31], v[80:95]
    v_mfma_f32_32x32x16_bf16 v[96:111], v[52:55], v[28:31], v[96:111]
    s_waitcnt lgkmcnt(0)
    ds_read_b128 v[28:31], v22
    ds_read_b64_tr_b16 v[44:45], v23 offset:9216
    ds_read_b64_tr_b16 v[46:47], v23 offset:9984
    ds_read_b64_tr_b16 v[48:49], v23 offset:9280
    ds_read_b64_tr_b16 v[50:51], v23 offset:10048
    ds_read_b64_tr_b16 v[52:53], v23 offset:21504
    ds_read_b64_tr_b16 v[54:55], v23 offset:22272
    v_mfma_f32_32x32x16_bf16 v[64:79], v[32:35], v[24:27], v[64:79]
    v_mfma_f32_32x32x16_bf16 v[80:95], v[36:39], v[24:27], v[80:95]
    v_mfma_f32_32x32x16_bf16 v[96:111], v[40:43], v[24:27], v[96:111]
    s_waitcnt lgkmcnt(0)
    s_barrier
    v_add_u32 v19, 40960, v14
    v_add_u32 v20, 40960, v15
    v_add_u32 v21, 40960, v16
    v_add_u32 v22, 40960, v17
    v_add_u32 v23, 57344, v18
    ds_read_b128 v[24:27], v19
    ds_read_b64_tr_b16 v[32:33], v23 offset:0
    ds_read_b64_tr_b16 v[34:35], v23 offset:768
    ds_read_b64_tr_b16 v[36:37], v23 offset:64
    ds_read_b64_tr_b16 v[38:39], v23 offset:832
    ds_read_b64_tr_b16 v[40:41], v23 offset:12288
    ds_read_b64_tr_b16 v[42:43], v23 offset:13056
    v_mfma_f32_32x32x16_bf16 v[64:79], v[44:47], v[28:31], v[64:79]
    v_mfma_f32_32x32x16_bf16 v[80:95], v[48:51], v[28:31], v[80:95]
    v_mfma_f32_32x32x16_bf16 v[96:111], v[52:55], v[28:31], v[96:111]
    s_waitcnt lgkmcnt(0)
    ds_read_b128 v[28:31], v20
    ds_read_b64_tr_b16 v[44:45], v23 offset:3072
    ds_read_b64_tr_b16 v[46:47], v23 offset:3840
    ds_read_b64_tr_b16 v[48:49], v23 offset:3136
    ds_read_b64_tr_b16 v[50:51], v23 offset:3904
    ds_read_b64_tr_b16 v[52:53], v23 offset:15360
    ds_read_b64_tr_b16 v[54:55], v23 offset:16128
    v_mfma_f32_32x32x16_bf16 v[64:79], v[32:35], v[24:27], v[64:79]
    v_mfma_f32_32x32x16_bf16 v[80:95], v[36:39], v[24:27], v[80:95]
    v_mfma_f32_32x32x16_bf16 v[96:111], v[40:43], v[24:27], v[96:111]
    s_waitcnt lgkmcnt(0)
    ds_read_b128 v[24:27], v21
    ds_read_b64_tr_b16 v[32:33], v23 offset:6144
    ds_read_b64_tr_b16 v[34:35], v23 offset:6912
    ds_read_b64_tr_b16 v[36:37], v23 offset:6208
    ds_read_b64_tr_b16 v[38:39], v23 offset:6976
    ds_read_b64_tr_b16 v[40:41], v23 offset:18432
    ds_read_b64_tr_b16 v[42:43], v23 offset:19200
    v_mfma_f32_32x32x16_bf16 v[64:79], v[44:47], v[28:31], v[64:79]
    v_mfma_f32_32x32x16_bf16 v[80:95], v[48:51], v[28:31], v[80:95]
    v_mfma_f32_32x32x16_bf16 v[96:111], v[52:55], v[28:31], v[96:111]
    s_waitcnt lgkmcnt(0)
    ds_read_b128 v[28:31], v22
    ds_read_b64_tr_b16 v[44:45], v23 offset:9216
    ds_read_b64_tr_b16 v[46:47], v23 offset:9984
    ds_read_b64_tr_b16 v[48:49], v23 offset:9280
    ds_read_b64_tr_b16 v[50:51], v23 offset:10048
    ds_read_b64_tr_b16 v[52:53], v23 offset:21504
    ds_read_b64_tr_b16 v[54:55], v23 offset:22272
    v_mfma_f32_32x32x16_bf16 v[64:79], v[32:35], v[24:27], v[64:79]
    v_mfma_f32_32x32x16_bf16 v[80:95], v[36:39], v[24:27], v[80:95]
    v_mfma_f32_32x32x16_bf16 v[96:111], v[40:43], v[24:27], v[96:111]
    s_waitcnt lgkmcnt(0)
    s_barrier
    v_add_u32 v19, 81920, v14
    v_add_u32 v20, 81920, v15
    v_add_u32 v21, 81920, v16
    v_add_u32 v22, 81920, v17
    v_add_u32 v23, 98304, v18
    ds_read_b128 v[24:27], v19
    ds_read_b64_tr_b16 v[32:33], v23 offset:0
    ds_read_b64_tr_b16 v[34:35], v23 offset:768
    ds_read_b64_tr_b16 v[36:37], v23 offset:64
    ds_read_b64_tr_b16 v[38:39], v23 offset:832
    ds_read_b64_tr_b16 v[40:41], v23 offset:12288
    ds_read_b64_tr_b16 v[42:43], v23 offset:13056
    v_mfma_f32_32x32x16_bf16 v[64:79], v[44:47], v[28:31], v[64:79]
    v_mfma_f32_32x32x16_bf16 v[80:95], v[48:51], v[28:31], v[80:95]
    v_mfma_f32_32x32x16_bf16 v[96:111], v[52:55], v[28:31], v[96:111]
    s_waitcnt lgkmcnt(0)
    ds_read_b128 v[28:31], v20
    ds_read_b64_tr_b16 v[44:45], v23 offset:3072
    ds_read_b64_tr_b16 v[46:47], v23 offset:3840
    ds_read_b64_tr_b16 v[48:49], v23 offset:3136
    ds_read_b64_tr_b16 v[50:51], v23 offset:3904
    ds_read_b64_tr_b16 v[52:53], v23 offset:15360
    ds_read_b64_tr_b16 v[54:55], v23 offset:16128
    v_mfma_f32_32x32x16_bf16 v[64:79], v[32:35], v[24:27], v[64:79]
    v_mfma_f32_32x32x16_bf16 v[80:95], v[36:39], v[24:27], v[80:95]
    v_mfma_f32_32x32x16_bf16 v[96:111], v[40:43], v[24:27], v[96:111]
    s_waitcnt lgkmcnt(0)
    ds_read_b128 v[24:27], v21
    ds_read_b64_tr_b16 v[32:33], v23 offset:6144
    ds_read_b64_tr_b16 v[34:35], v23 offset:6912
    ds_read_b64_tr_b16 v[36:37], v23 offset:6208
    ds_read_b64_tr_b16 v[38:39], v23 offset:6976
    ds_read_b64_tr_b16 v[40:41], v23 offset:18432
    ds_read_b64_tr_b16 v[42:43], v23 offset:19200
    v_mfma_f32_32x32x16_bf16 v[64:79], v[44:47], v[28:31], v[64:79]
    v_mfma_f32_32x32x16_bf16 v[80:95], v[48:51], v[28:31], v[80:95]
    v_mfma_f32_32x32x16_bf16 v[96:111], v[52:55], v[28:31], v[96:111]
    s_waitcnt lgkmcnt(0)
    ds_read_b128 v[28:31], v22
    ds_read_b64_tr_b16 v[44:45], v23 offset:9216
    ds_read_b64_tr_b16 v[46:47], v23 offset:9984
    ds_read_b64_tr_b16 v[48:49], v23 offset:9280
    ds_read_b64_tr_b16 v[50:51], v23 offset:10048
    ds_read_b64_tr_b16 v[52:53], v23 offset:21504
    ds_read_b64_tr_b16 v[54:55], v23 offset:22272
    v_mfma_f32_32x32x16_bf16 v[64:79], v[32:35], v[24:27], v[64:79]
    v_mfma_f32_32x32x16_bf16 v[80:95], v[36:39], v[24:27], v[80:95]
    v_mfma_f32_32x32x16_bf16 v[96:111], v[40:43], v[24:27], v[96:111]
    s_waitcnt lgkmcnt(0)
    s_barrier
    v_add_u32 v19, 0, v14
    v_add_u32 v20, 0, v15
    v_add_u32 v21, 0, v16
    v_add_u32 v22, 0, v17
    v_add_u32 v23, 16384, v18
    ds_read_b128 v[24:27], v19
    ds_read_b64_tr_b16 v[32:33], v23 offset:0
    ds_read_b64_tr_b16 v[34:35], v23 offset:768
    ds_read_b64_tr_b16 v[36:37], v23 offset:64
    ds_read_b64_tr_b16 v[38:39], v23 offset:832
    ds_read_b64_tr_b16 v[40:41], v23 offset:12288
    ds_read_b64_tr_b16 v[42:43], v23 offset:13056
    v_mfma_f32_32x32x16_bf16 v[64:79], v[44:47], v[28:31], v[64:79]
    v_mfma_f32_32x32x16_bf16 v[80:95], v[48:51], v[28:31], v[80:95]
    v_mfma_f32_32x32x16_bf16 v[96:111], v[52:55], v[28:31], v[96:111]
    s_waitcnt lgkmcnt(0)
    ds_read_b128 v[28:31], v20
    ds_read_b64_tr_b16 v[44:45], v23 offset:3072
    ds_read_b64_tr_b16 v[46:47], v23 offset:3840
    ds_read_b64_tr_b16 v[48:49], v23 offset:3136
    ds_read_b64_tr_b16 v[50:51], v23 offset:3904
    ds_read_b64_tr_b16 v[52:53], v23 offset:15360
    ds_read_b64_tr_b16 v[54:55], v23 offset:16128
    v_mfma_f32_32x32x16_bf16 v[64:79], v[32:35], v[24:27], v[64:79]
    v_mfma_f32_32x32x16_bf16 v[80:95], v[36:39], v[24:27], v[80:95]
    v_mfma_f32_32x32x16_bf16 v[96:111], v[40:43], v[24:27], v[96:111]
    s_waitcnt lgkmcnt(0)
    ds_read_b128 v[24:27], v21
    ds_read_b64_tr_b16 v[32:33], v23 offset:6144
    ds_read_b64_tr_b16 v[34:35], v23 offset:6912
    ds_read_b64_tr_b16 v[36:37], v23 offset:6208
    ds_read_b64_tr_b16 v[38:39], v23 offset:6976
    ds_read_b64_tr_b16 v[40:41], v23 offset:18432
    ds_read_b64_tr_b16 v[42:43], v23 offset:19200
    v_mfma_f32_32x32x16_bf16 v[64:79], v[44:47], v[28:31], v[64:79]
    v_mfma_f32_32x32x16_bf16 v[80:95], v[48:51], v[28:31], v[80:95]
    v_mfma_f32_32x32x16_bf16 v[96:111], v[52:55], v[28:31], v[96:111]
    s_waitcnt lgkmcnt(0)
    ds_read_b128 v[28:31], v22
    ds_read_b64_tr_b16 v[44:45], v23 offset:9216
    ds_read_b64_tr_b16 v[46:47], v23 offset:9984
    ds_read_b64_tr_b16 v[48:49], v23 offset:9280
    ds_read_b64_tr_b16 v[50:51], v23 offset:10048
    ds_read_b64_tr_b16 v[52:53], v23 offset:21504
    ds_read_b64_tr_b16 v[54:55], v23 offset:22272
    v_mfma_f32_32x32x16_bf16 v[64:79], v[32:35], v[24:27], v[64:79]
    v_mfma_f32_32x32x16_bf16 v[80:95], v[36:39], v[24:27], v[80:95]
    v_mfma_f32_32x32x16_bf16 v[96:111], v[40:43], v[24:27], v[96:111]
    s_waitcnt lgkmcnt(0)
    s_barrier
    v_add_u32 v19, 40960, v14
    v_add_u32 v20, 40960, v15
    v_add_u32 v21, 40960, v16
    v_add_u32 v22, 40960, v17
    v_add_u32 v23, 57344, v18
    ds_read_b128 v[24:27], v19
    ds_read_b64_tr_b16 v[32:33], v23 offset:0
    ds_read_b64_tr_b16 v[34:35], v23 offset:768
    ds_read_b64_tr_b16 v[36:37], v23 offset:64
    ds_read_b64_tr_b16 v[38:39], v23 offset:832
    ds_read_b64_tr_b16 v[40:41], v23 offset:12288
    ds_read_b64_tr_b16 v[42:43], v23 offset:13056
    v_mfma_f32_32x32x16_bf16 v[64:79], v[44:47], v[28:31], v[64:79]
    v_mfma_f32_32x32x16_bf16 v[80:95], v[48:51], v[28:31], v[80:95]
    v_mfma_f32_32x32x16_bf16 v[96:111], v[52:55], v[28:31], v[96:111]
    s_waitcnt lgkmcnt(0)
    ds_read_b128 v[28:31], v20
    ds_read_b64_tr_b16 v[44:45], v23 offset:3072
    ds_read_b64_tr_b16 v[46:47], v23 offset:3840
    ds_read_b64_tr_b16 v[48:49], v23 offset:3136
    ds_read_b64_tr_b16 v[50:51], v23 offset:3904
    ds_read_b64_tr_b16 v[52:53], v23 offset:15360
    ds_read_b64_tr_b16 v[54:55], v23 offset:16128
    v_mfma_f32_32x32x16_bf16 v[64:79], v[32:35], v[24:27], v[64:79]
    v_mfma_f32_32x32x16_bf16 v[80:95], v[36:39], v[24:27], v[80:95]
    v_mfma_f32_32x32x16_bf16 v[96:111], v[40:43], v[24:27], v[96:111]
    s_waitcnt lgkmcnt(0)
    ds_read_b128 v[24:27], v21
    ds_read_b64_tr_b16 v[32:33], v23 offset:6144
    ds_read_b64_tr_b16 v[34:35], v23 offset:6912
    ds_read_b64_tr_b16 v[36:37], v23 offset:6208
    ds_read_b64_tr_b16 v[38:39], v23 offset:6976
    ds_read_b64_tr_b16 v[40:41], v23 offset:18432
    ds_read_b64_tr_b16 v[42:43], v23 offset:19200
    v_mfma_f32_32x32x16_bf16 v[64:79], v[44:47], v[28:31], v[64:79]
    v_mfma_f32_32x32x16_bf16 v[80:95], v[48:51], v[28:31], v[80:95]
    v_mfma_f32_32x32x16_bf16 v[96:111], v[52:55], v[28:31], v[96:111]
    s_waitcnt lgkmcnt(0)
    ds_read_b128 v[28:31], v22
    ds_read_b64_tr_b16 v[44:45], v23 offset:9216
    ds_read_b64_tr_b16 v[46:47], v23 offset:9984
    ds_read_b64_tr_b16 v[48:49], v23 offset:9280
    ds_read_b64_tr_b16 v[50:51], v23 offset:10048
    ds_read_b64_tr_b16 v[52:53], v23 offset:21504
    ds_read_b64_tr_b16 v[54:55], v23 offset:22272
    v_mfma_f32_32x32x16_bf16 v[64:79], v[32:35], v[24:27], v[64:79]
    v_mfma_f32_32x32x16_bf16 v[80:95], v[36:39], v[24:27], v[80:95]
    v_mfma_f32_32x32x16_bf16 v[96:111], v[40:43], v[24:27], v[96:111]
    s_waitcnt lgkmcnt(0)
    s_barrier
    v_add_u32 v19, 81920, v14
    v_add_u32 v20, 81920, v15
    v_add_u32 v21, 81920, v16
    v_add_u32 v22, 81920, v17
    v_add_u32 v23, 98304, v18
    ds_read_b128 v[24:27], v19
    ds_read_b64_tr_b16 v[32:33], v23 offset:0
    ds_read_b64_tr_b16 v[34:35], v23 offset:768
    ds_read_b64_tr_b16 v[36:37], v23 offset:64
    ds_read_b64_tr_b16 v[38:39], v23 offset:832
    ds_read_b64_tr_b16 v[40:41], v23 offset:12288
    ds_read_b64_tr_b16 v[42:43], v23 offset:13056
    v_mfma_f32_32x32x16_bf16 v[64:79], v[44:47], v[28:31], v[64:79]
    v_mfma_f32_32x32x16_bf16 v[80:95], v[48:51], v[28:31], v[80:95]
    v_mfma_f32_32x32x16_bf16 v[96:111], v[52:55], v[28:31], v[96:111]
    s_waitcnt lgkmcnt(0)
    ds_read_b128 v[28:31], v20
    ds_read_b64_tr_b16 v[44:45], v23 offset:3072
    ds_read_b64_tr_b16 v[46:47], v23 offset:3840
    ds_read_b64_tr_b16 v[48:49], v23 offset:3136
    ds_read_b64_tr_b16 v[50:51], v23 offset:3904
    ds_read_b64_tr_b16 v[52:53], v23 offset:15360
    ds_read_b64_tr_b16 v[54:55], v23 offset:16128
    v_mfma_f32_32x32x16_bf16 v[64:79], v[32:35], v[24:27], v[64:79]
    v_mfma_f32_32x32x16_bf16 v[80:95], v[36:39], v[24:27], v[80:95]
    v_mfma_f32_32x32x16_bf16 v[96:111], v[40:43], v[24:27], v[96:111]
    s_waitcnt lgkmcnt(0)
    ds_read_b128 v[24:27], v21
    ds_read_b64_tr_b16 v[32:33], v23 offset:6144
    ds_read_b64_tr_b16 v[34:35], v23 offset:6912
    ds_read_b64_tr_b16 v[36:37], v23 offset:6208
    ds_read_b64_tr_b16 v[38:39], v23 offset:6976
    ds_read_b64_tr_b16 v[40:41], v23 offset:18432
    ds_read_b64_tr_b16 v[42:43], v23 offset:19200
    v_mfma_f32_32x32x16_bf16 v[64:79], v[44:47], v[28:31], v[64:79]
    v_mfma_f32_32x32x16_bf16 v[80:95], v[48:51], v[28:31], v[80:95]
    v_mfma_f32_32x32x16_bf16 v[96:111], v[52:55], v[28:31], v[96:111]
    s_waitcnt lgkmcnt(0)
    ds_read_b128 v[28:31], v22
    ds_read_b64_tr_b16 v[44:45], v23 offset:9216
    ds_read_b64_tr_b16 v[46:47], v23 offset:9984
    ds_read_b64_tr_b16 v[48:49], v23 offset:9280
    ds_read_b64_tr_b16 v[50:51], v23 offset:10048
    ds_read_b64_tr_b16 v[52:53], v23 offset:21504
    ds_read_b64_tr_b16 v[54:55], v23 offset:22272
    v_mfma_f32_32x32x16_bf16 v[64:79], v[32:35], v[24:27], v[64:79]
    v_mfma_f32_32x32x16_bf16 v[80:95], v[36:39], v[24:27], v[80:95]
    v_mfma_f32_32x32x16_bf16 v[96:111], v[40:43], v[24:27], v[96:111]
    s_waitcnt lgkmcnt(0)
    s_barrier
    v_add_u32 v19, 0, v14
    v_add_u32 v20, 0, v15
    v_add_u32 v21, 0, v16
    v_add_u32 v22, 0, v17
    v_add_u32 v23, 16384, v18
    ds_read_b128 v[24:27], v19
    ds_read_b64_tr_b16 v[32:33], v23 offset:0
    ds_read_b64_tr_b16 v[34:35], v23 offset:768
    ds_read_b64_tr_b16 v[36:37], v23 offset:64
    ds_read_b64_tr_b16 v[38:39], v23 offset:832
    ds_read_b64_tr_b16 v[40:41], v23 offset:12288
    ds_read_b64_tr_b16 v[42:43], v23 offset:13056
    v_mfma_f32_32x32x16_bf16 v[64:79], v[44:47], v[28:31], v[64:79]
    v_mfma_f32_32x32x16_bf16 v[80:95], v[48:51], v[28:31], v[80:95]
    v_mfma_f32_32x32x16_bf16 v[96:111], v[52:55], v[28:31], v[96:111]
    s_waitcnt lgkmcnt(0)
    ds_read_b128 v[28:31], v20
    ds_read_b64_tr_b16 v[44:45], v23 offset:3072
    ds_read_b64_tr_b16 v[46:47], v23 offset:3840
    ds_read_b64_tr_b16 v[48:49], v23 offset:3136
    ds_read_b64_tr_b16 v[50:51], v23 offset:3904
    ds_read_b64_tr_b16 v[52:53], v23 offset:15360
    ds_read_b64_tr_b16 v[54:55], v23 offset:16128
    v_mfma_f32_32x32x16_bf16 v[64:79], v[32:35], v[24:27], v[64:79]
    v_mfma_f32_32x32x16_bf16 v[80:95], v[36:39], v[24:27], v[80:95]
    v_mfma_f32_32x32x16_bf16 v[96:111], v[40:43], v[24:27], v[96:111]
    s_waitcnt lgkmcnt(0)
    ds_read_b128 v[24:27], v21
    ds_read_b64_tr_b16 v[32:33], v23 offset:6144
    ds_read_b64_tr_b16 v[34:35], v23 offset:6912
    ds_read_b64_tr_b16 v[36:37], v23 offset:6208
    ds_read_b64_tr_b16 v[38:39], v23 offset:6976
    ds_read_b64_tr_b16 v[40:41], v23 offset:18432
    ds_read_b64_tr_b16 v[42:43], v23 offset:19200
    v_mfma_f32_32x32x16_bf16 v[64:79], v[44:47], v[28:31], v[64:79]
    v_mfma_f32_32x32x16_bf16 v[80:95], v[48:51], v[28:31], v[80:95]
    v_mfma_f32_32x32x16_bf16 v[96:111], v[52:55], v[28:31], v[96:111]
    s_waitcnt lgkmcnt(0)
    ds_read_b128 v[28:31], v22
    ds_read_b64_tr_b16 v[44:45], v23 offset:9216
    ds_read_b64_tr_b16 v[46:47], v23 offset:9984
    ds_read_b64_tr_b16 v[48:49], v23 offset:9280
    ds_read_b64_tr_b16 v[50:51], v23 offset:10048
    ds_read_b64_tr_b16 v[52:53], v23 offset:21504
    ds_read_b64_tr_b16 v[54:55], v23 offset:22272
    v_mfma_f32_32x32x16_bf16 v[64:79], v[32:35], v[24:27], v[64:79]
    v_mfma_f32_32x32x16_bf16 v[80:95], v[36:39], v[24:27], v[80:95]
    v_mfma_f32_32x32x16_bf16 v[96:111], v[40:43], v[24:27], v[96:111]
    s_waitcnt lgkmcnt(0)
    s_barrier
    v_add_u32 v19, 40960, v14
    v_add_u32 v20, 40960, v15
    v_add_u32 v21, 40960, v16
    v_add_u32 v22, 40960, v17
    v_add_u32 v23, 57344, v18
    ds_read_b128 v[24:27], v19
    ds_read_b64_tr_b16 v[32:33], v23 offset:0
    ds_read_b64_tr_b16 v[34:35], v23 offset:768
    ds_read_b64_tr_b16 v[36:37], v23 offset:64
    ds_read_b64_tr_b16 v[38:39], v23 offset:832
    ds_read_b64_tr_b16 v[40:41], v23 offset:12288
    ds_read_b64_tr_b16 v[42:43], v23 offset:13056
    v_mfma_f32_32x32x16_bf16 v[64:79], v[44:47], v[28:31], v[64:79]
    v_mfma_f32_32x32x16_bf16 v[80:95], v[48:51], v[28:31], v[80:95]
    v_mfma_f32_32x32x16_bf16 v[96:111], v[52:55], v[28:31], v[96:111]
    s_waitcnt lgkmcnt(0)
    ds_read_b128 v[28:31], v20
    ds_read_b64_tr_b16 v[44:45], v23 offset:3072
    ds_read_b64_tr_b16 v[46:47], v23 offset:3840
    ds_read_b64_tr_b16 v[48:49], v23 offset:3136
    ds_read_b64_tr_b16 v[50:51], v23 offset:3904
    ds_read_b64_tr_b16 v[52:53], v23 offset:15360
    ds_read_b64_tr_b16 v[54:55], v23 offset:16128
    v_mfma_f32_32x32x16_bf16 v[64:79], v[32:35], v[24:27], v[64:79]
    v_mfma_f32_32x32x16_bf16 v[80:95], v[36:39], v[24:27], v[80:95]
    v_mfma_f32_32x32x16_bf16 v[96:111], v[40:43], v[24:27], v[96:111]
    s_waitcnt lgkmcnt(0)
    ds_read_b128 v[24:27], v21
    ds_read_b64_tr_b16 v[32:33], v23 offset:6144
    ds_read_b64_tr_b16 v[34:35], v23 offset:6912
    ds_read_b64_tr_b16 v[36:37], v23 offset:6208
    ds_read_b64_tr_b16 v[38:39], v23 offset:6976
    ds_read_b64_tr_b16 v[40:41], v23 offset:18432
    ds_read_b64_tr_b16 v[42:43], v23 offset:19200
    v_mfma_f32_32x32x16_bf16 v[64:79], v[44:47], v[28:31], v[64:79]
    v_mfma_f32_32x32x16_bf16 v[80:95], v[48:51], v[28:31], v[80:95]
    v_mfma_f32_32x32x16_bf16 v[96:111], v[52:55], v[28:31], v[96:111]
    s_waitcnt lgkmcnt(0)
    ds_read_b128 v[28:31], v22
    ds_read_b64_tr_b16 v[44:45], v23 offset:9216
    ds_read_b64_tr_b16 v[46:47], v23 offset:9984
    ds_read_b64_tr_b16 v[48:49], v23 offset:9280
    ds_read_b64_tr_b16 v[50:51], v23 offset:10048
    ds_read_b64_tr_b16 v[52:53], v23 offset:21504
    ds_read_b64_tr_b16 v[54:55], v23 offset:22272
    v_mfma_f32_32x32x16_bf16 v[64:79], v[32:35], v[24:27], v[64:79]
    v_mfma_f32_32x32x16_bf16 v[80:95], v[36:39], v[24:27], v[80:95]
    v_mfma_f32_32x32x16_bf16 v[96:111], v[40:43], v[24:27], v[96:111]
    s_waitcnt lgkmcnt(0)
    v_mfma_f32_32x32x16_bf16 v[64:79], v[44:47], v[28:31], v[64:79]
    v_mfma_f32_32x32x16_bf16 v[80:95], v[48:51], v[28:31], v[80:95]
    v_mfma_f32_32x32x16_bf16 v[96:111], v[52:55], v[28:31], v[96:111]
    v_and_b32 v26, 31, v1
    v_lshrrev_b32 v27, 5, v1
    s_lshl_b32 s44, s36, 2
    s_add_u32 s46, s44, s40
    v_lshlrev_b32 v24, 4, v1
    s_waitcnt vmcnt(0)
    s_nop 7
    v_mul_f32 v64, 0x3eb8aa3b, v64
    v_mul_f32 v65, 0x3eb8aa3b, v65
    v_mul_f32 v66, 0x3eb8aa3b, v66
    v_mul_f32 v67, 0x3eb8aa3b, v67
    v_mul_f32 v68, 0x3eb8aa3b, v68
    v_mul_f32 v69, 0x3eb8aa3b, v69
    v_mul_f32 v70, 0x3eb8aa3b, v70
    v_mul_f32 v71, 0x3eb8aa3b, v71
    v_mul_f32 v72, 0x3eb8aa3b, v72
    v_mul_f32 v73, 0x3eb8aa3b, v73
    v_mul_f32 v74, 0x3eb8aa3b, v74
    v_mul_f32 v75, 0x3eb8aa3b, v75
    v_mul_f32 v76, 0x3eb8aa3b, v76
    v_mul_f32 v77, 0x3eb8aa3b, v77
    v_mul_f32 v78, 0x3eb8aa3b, v78
    v_mul_f32 v79, 0x3eb8aa3b, v79
    v_cvt_pk_bf16_f32 v28, v64, v65
    v_cvt_pk_bf16_f32 v29, v66, v67
    v_cvt_pk_bf16_f32 v30, v68, v69
    v_cvt_pk_bf16_f32 v31, v70, v71
    v_cvt_pk_bf16_f32 v32, v72, v73
    v_cvt_pk_bf16_f32 v33, v74, v75
    v_cvt_pk_bf16_f32 v34, v76, v77
    v_cvt_pk_bf16_f32 v35, v78, v79
    s_lshl_b32 s47, s37, 17
    s_lshl_b32 s48, s46, 10
    s_add_u32 s47, s47, s48
    s_add_u32 s47, s47, 0
    buffer_store_dwordx4 v[28:31], v24, s[32:35], s47 offen sc1
    s_add_u32 s47, s47, 65536
    buffer_store_dwordx4 v[32:35], v24, s[32:35], s47 offen sc1
    s_nop 1
    v_cvt_pk_bf16_f32 v28, v80, v81
    v_cvt_pk_bf16_f32 v29, v82, v83
    v_cvt_pk_bf16_f32 v30, v84, v85
    v_cvt_pk_bf16_f32 v31, v86, v87
    v_cvt_pk_bf16_f32 v32, v88, v89
    v_cvt_pk_bf16_f32 v33, v90, v91
    v_cvt_pk_bf16_f32 v34, v92, v93
    v_cvt_pk_bf16_f32 v35, v94, v95
    s_lshl_b32 s47, s37, 17
    s_lshl_b32 s48, s46, 10
    s_add_u32 s47, s47, s48
    s_add_u32 s47, s47, 2097152
    buffer_store_dwordx4 v[28:31], v24, s[32:35], s47 offen sc1
    s_add_u32 s47, s47, 65536
    buffer_store_dwordx4 v[32:35], v24, s[32:35], s47 offen sc1
    s_nop 1
    s_add_u32 s47, s39, 0
    v_lshlrev_b32 v48, 16, v128
    v_and_b32 v49, 0xffff0000, v128
    v_lshlrev_b32 v50, 16, v129
    v_and_b32 v51, 0xffff0000, v129
    v_lshlrev_b32 v52, 16, v130
    v_and_b32 v53, 0xffff0000, v130
    v_lshlrev_b32 v54, 16, v131
    v_and_b32 v55, 0xffff0000, v131
    v_lshlrev_b32 v56, 16, v132
    v_and_b32 v57, 0xffff0000, v132
    v_lshlrev_b32 v58, 16, v133
    v_and_b32 v59, 0xffff0000, v133
    v_lshlrev_b32 v60, 16, v134
    v_and_b32 v61, 0xffff0000, v134
    v_lshlrev_b32 v62, 16, v135
    v_and_b32 v63, 0xffff0000, v135
    v_add_f32 v96, v96, v48
    v_add_f32 v97, v97, v49
    v_add_f32 v98, v98, v50
    v_add_f32 v99, v99, v51
    v_add_f32 v100, v100, v52
    v_add_f32 v101, v101, v53
    v_add_f32 v102, v102, v54
    v_add_f32 v103, v103, v55
    v_mul_f32 v112, 0x3fb8aa3b, v96
    v_mul_f32 v113, 0x3fb8aa3b, v97
    v_mul_f32 v114, 0x3fb8aa3b, v98
    v_mul_f32 v115, 0x3fb8aa3b, v99
    v_mul_f32 v116, 0x3fb8aa3b, v100
    v_mul_f32 v117, 0x3fb8aa3b, v101
    v_mul_f32 v118, 0x3fb8aa3b, v102
    v_mul_f32 v119, 0x3fb8aa3b, v103
    v_min_f32 v112, 0x41f00000, v112
    v_min_f32 v113, 0x41f00000, v113
    v_min_f32 v114, 0x41f00000, v114
    v_min_f32 v115, 0x41f00000, v115
    v_min_f32 v116, 0x41f00000, v116
    v_min_f32 v117, 0x41f00000, v117
    v_min_f32 v118, 0x41f00000, v118
    v_min_f32 v119, 0x41f00000, v119
    v_exp_f32 v112, v112
    v_exp_f32 v113, v113
    v_exp_f32 v114, v114
    v_exp_f32 v115, v115
    v_exp_f32 v116, v116
    v_exp_f32 v117, v117
    v_exp_f32 v118, v118
    v_exp_f32 v119, v119
    s_nop 0
    v_add_f32 v120, 2.0, v112
    v_add_f32 v121, 2.0, v113
    v_add_f32 v122, 2.0, v114
    v_add_f32 v123, 2.0, v115
    v_add_f32 v124, 2.0, v116
    v_add_f32 v125, 2.0, v117
    v_add_f32 v126, 2.0, v118
    v_add_f32 v127, 2.0, v119
    v_mul_f32 v120, v120, v112
    v_mul_f32 v121, v121, v113
    v_mul_f32 v122, v122, v114
    v_mul_f32 v123, v123, v115
    v_mul_f32 v124, v124, v116
    v_mul_f32 v125, v125, v117
    v_mul_f32 v126, v126, v118
    v_mul_f32 v127, v127, v119
    v_add_f32 v112, 2.0, v120
    v_add_f32 v113, 2.0, v121
    v_add_f32 v114, 2.0, v122
    v_add_f32 v115, 2.0, v123
    v_add_f32 v116, 2.0, v124
    v_add_f32 v117, 2.0, v125
    v_add_f32 v118, 2.0, v126
    v_add_f32 v119, 2.0, v127
    v_rcp_f32 v112, v112
    v_rcp_f32 v113, v113
    v_rcp_f32 v114, v114
    v_rcp_f32 v115, v115
    v_rcp_f32 v116, v116
    v_rcp_f32 v117, v117
    v_rcp_f32 v118, v118
    v_rcp_f32 v119, v119
    s_nop 0
    v_mul_f32 v120, v120, v112
    v_mul_f32 v121, v121, v113
    v_mul_f32 v122, v122, v114
    v_mul_f32 v123, v123, v115
    v_mul_f32 v124, v124, v116
    v_mul_f32 v125, v125, v117
    v_mul_f32 v126, v126, v118
    v_mul_f32 v127, v127, v119
    v_mul_f32 v96, v96, v120
    v_mul_f32 v97, v97, v121
    v_mul_f32 v98, v98, v122
    v_mul_f32 v99, v99, v123
    v_mul_f32 v100, v100, v124
    v_mul_f32 v101, v101, v125
    v_mul_f32 v102, v102, v126
    v_mul_f32 v103, v103, v127
    v_add_f32 v104, v104, v56
    v_add_f32 v105, v105, v57
    v_add_f32 v106, v106, v58
    v_add_f32 v107, v107, v59
    v_add_f32 v108, v108, v60
    v_add_f32 v109, v109, v61
    v_add_f32 v110, v110, v62
    v_add_f32 v111, v111, v63
    v_mul_f32 v112, 0x3fb8aa3b, v104
    v_mul_f32 v113, 0x3fb8aa3b, v105
    v_mul_f32 v114, 0x3fb8aa3b, v106
    v_mul_f32 v115, 0x3fb8aa3b, v107
    v_mul_f32 v116, 0x3fb8aa3b, v108
    v_mul_f32 v117, 0x3fb8aa3b, v109
    v_mul_f32 v118, 0x3fb8aa3b, v110
    v_mul_f32 v119, 0x3fb8aa3b, v111
    v_min_f32 v112, 0x41f00000, v112
    v_min_f32 v113, 0x41f00000, v113
    v_min_f32 v114, 0x41f00000, v114
    v_min_f32 v115, 0x41f00000, v115
    v_min_f32 v116, 0x41f00000, v116
    v_min_f32 v117, 0x41f00000, v117
    v_min_f32 v118, 0x41f00000, v118
    v_min_f32 v119, 0x41f00000, v119
    v_exp_f32 v112, v112
    v_exp_f32 v113, v113
    v_exp_f32 v114, v114
    v_exp_f32 v115, v115
    v_exp_f32 v116, v116
    v_exp_f32 v117, v117
    v_exp_f32 v118, v118
    v_exp_f32 v119, v119
    s_nop 0
    v_add_f32 v120, 2.0, v112
    v_add_f32 v121, 2.0, v113
    v_add_f32 v122, 2.0, v114
    v_add_f32 v123, 2.0, v115
    v_add_f32 v124, 2.0, v116
    v_add_f32 v125, 2.0, v117
    v_add_f32 v126, 2.0, v118
    v_add_f32 v127, 2.0, v119
    v_mul_f32 v120, v120, v112
    v_mul_f32 v121, v121, v113
    v_mul_f32 v122, v122, v114
    v_mul_f32 v123, v123, v115
    v_mul_f32 v124, v124, v116
    v_mul_f32 v125, v125, v117
    v_mul_f32 v126, v126, v118
    v_mul_f32 v127, v127, v119
    v_add_f32 v112, 2.0, v120
    v_add_f32 v113, 2.0, v121
    v_add_f32 v114, 2.0, v122
    v_add_f32 v115, 2.0, v123
    v_add_f32 v116, 2.0, v124
    v_add_f32 v117, 2.0, v125
    v_add_f32 v118, 2.0, v126
    v_add_f32 v119, 2.0, v127
    v_rcp_f32 v112, v112
    v_rcp_f32 v113, v113
    v_rcp_f32 v114, v114
    v_rcp_f32 v115, v115
    v_rcp_f32 v116, v116
    v_rcp_f32 v117, v117
    v_rcp_f32 v118, v118
    v_rcp_f32 v119, v119
    s_nop 0
    v_mul_f32 v120, v120, v112
    v_mul_f32 v121, v121, v113
    v_mul_f32 v122, v122, v114
    v_mul_f32 v123, v123, v115
    v_mul_f32 v124, v124, v116
    v_mul_f32 v125, v125, v117
    v_mul_f32 v126, v126, v118
    v_mul_f32 v127, v127, v119
    v_mul_f32 v104, v104, v120
    v_mul_f32 v105, v105, v121
    v_mul_f32 v106, v106, v122
    v_mul_f32 v107, v107, v123
    v_mul_f32 v108, v108, v124
    v_mul_f32 v109, v109, v125
    v_mul_f32 v110, v110, v126
    v_mul_f32 v111, v111, v127
    v_cvt_pk_bf16_f32 v28, v96, v97
    v_cvt_pk_bf16_f32 v29, v98, v99
    v_cvt_pk_bf16_f32 v30, v100, v101
    v_cvt_pk_bf16_f32 v31, v102, v103
    v_cvt_pk_bf16_f32 v32, v104, v105
    v_cvt_pk_bf16_f32 v33, v106, v107
    v_cvt_pk_bf16_f32 v34, v108, v109
    v_cvt_pk_bf16_f32 v35, v110, v111
    s_mul_i32 s48, s46, 86
    s_lshr_b32 s49, s47, 4
    s_add_u32 s48, s48, s49
    s_lshl_b32 s48, s48, 10
    s_add_u32 s48, s48, 6291456
    buffer_store_dwordx4 v[28:31], v24, s[32:35], s48 offen
    buffer_store_dwordx4 v[32:35], v24, s[32:35], s48 offen offset:1024
    s_nop 1
    s_endpgm
K1_NH1:
    v_lshrrev_b32 v2, 5, v1
    v_lshlrev_b32 v2, 3, v2
    s_add_u32 s47, s39, 32
    s_lshl_b32 s49, s47, 1
    buffer_load_dwordx2 v[128:129], v2, s[28:31], s49 offen offset:0
    buffer_load_dwordx2 v[130:131], v2, s[28:31], s49 offen offset:16
    buffer_load_dwordx2 v[132:133], v2, s[28:31], s49 offen offset:32
    buffer_load_dwordx2 v[134:135], v2, s[28:31], s49 offen offset:48
    s_add_u32 s47, s39, 64
    s_lshl_b32 s49, s47, 1
    buffer_load_dwordx2 v[136:137], v2, s[28:31], s49 offen offset:0
    buffer_load_dwordx2 v[138:139], v2, s[28:31], s49 offen offset:16
    buffer_load_dwordx2 v[140:141], v2, s[28:31], s49 offen offset:32
    buffer_load_dwordx2 v[142:143], v2, s[28:31], s49 offen offset:48
    s_barrier
    v_add_u32 v19, 0, v14
    v_add_u32 v20, 0, v15
    v_add_u32 v21, 0, v16
    v_add_u32 v22, 0, v17
    v_add_u32 v23, 16384, v18
    ds_read_b128 v[24:27], v19
    ds_read_b64_tr_b16 v[32:33], v23 offset:128
    ds_read_b64_tr_b16 v[34:35], v23 offset:896
    ds_read_b64_tr_b16 v[36:37], v23 offset:12352
    ds_read_b64_tr_b16 v[38:39], v23 offset:13120
    ds_read_b64_tr_b16 v[40:41], v23 offset:12416
    ds_read_b64_tr_b16 v[42:43], v23 offset:13184
    s_waitcnt lgkmcnt(0)
    ds_read_b128 v[28:31], v20
    ds_read_b64_tr_b16 v[44:45], v23 offset:3200
    ds_read_b64_tr_b16 v[46:47], v23 offset:3968
    ds_read_b64_tr_b16 v[48:49], v23 offset:15424
    ds_read_b64_tr_b16 v[50:51], v23 offset:16192
    ds_read_b64_tr_b16 v[52:53], v23 offset:15488
    ds_read_b64_tr_b16 v[54:55], v23 offset:16256
    v_mfma_f32_32x32x16_bf16 v[64:79], v[24:27], v[32:35], 0
    v_mfma_f32_32x32x16_bf16 v[80:95], v[36:39], v[24:27], 0
    v_mfma_f32_32x32x16_bf16 v[96:111], v[40:43], v[24:27], 0
    s_waitcnt lgkmcnt(0)
    ds_read_b128 v[24:27], v21
    ds_read_b64_tr_b16 v[32:33], v23 offset:6272
    ds_read_b64_tr_b16 v[34:35], v23 offset:7040
    ds_read_b64_tr_b16 v[36:37], v23 offset:18496
    ds_read_b64_tr_b16 v[38:39], v23 offset:19264
    ds_read_b64_tr_b16 v[40:41], v23 offset:18560
    ds_read_b64_tr_b16 v[42:43], v23 offset:19328
    v_mfma_f32_32x32x16_bf16 v[64:79], v[28:31], v[44:47], v[64:79]
    v_mfma_f32_32x32x16_bf16 v[80:95], v[48:51], v[28:31], v[80:95]
    v_mfma_f32_32x32x16_bf16 v[96:111], v[52:55], v[28:31], v[96:111]
    s_waitcnt lgkmcnt(0)
    ds_read_b128 v[28:31], v22
    ds_read_b64_tr_b16 v[44:45], v23 offset:9344
    ds_read_b64_tr_b16 v[46:47], v23 offset:10112
    ds_read_b64_tr_b16 v[48:49], v23 offset:21568
    ds_read_b64_tr_b16 v[50:51], v23 offset:22336
    ds_read_b64_tr_b16 v[52:53], v23 offset:21632
    ds_read_b64_tr_b16 v[54:55], v23 offset:22400
    v_mfma_f32_32x32x16_bf16 v[64:79], v[24:27], v[32:35], v[64:79]
    v_mfma_f32_32x32x16_bf16 v[80:95], v[36:39], v[24:27], v[80:95]
    v_mfma_f32_32x32x16_bf16 v[96:111], v[40:43], v[24:27], v[96:111]
    s_waitcnt lgkmcnt(0)
    s_barrier
    v_add_u32 v19, 40960, v14
    v_add_u32 v20, 40960, v15
    v_add_u32 v21, 40960, v16
    v_add_u32 v22, 40960, v17
    v_add_u32 v23, 57344, v18
    ds_read_b128 v[24:27], v19
    ds_read_b64_tr_b16 v[32:33], v23 offset:128
    ds_read_b64_tr_b16 v[34:35], v23 offset:896
    ds_read_b64_tr_b16 v[36:37], v23 offset:12352
    ds_read_b64_tr_b16 v[38:39], v23 offset:13120
    ds_read_b64_tr_b16 v[40:41], v23 offset:12416
    ds_read_b64_tr_b16 v[42:43], v23 offset:13184
    v_mfma_f32_32x32x16_bf16 v[64:79], v[28:31], v[44:47], v[64:79]
    v_mfma_f32_32x32x16_bf16 v[80:95], v[48:51], v[28:31], v[80:95]
    v_mfma_f32_32x32x16_bf16 v[96:111], v[52:55], v[28:31], v[96:111]
    s_waitcnt lgkmcnt(0)
    ds_read_b128 v[28:31], v20
    ds_read_b64_tr_b16 v[44:45], v23 offset:3200
    ds_read_b64_tr_b16 v[46:47], v23 offset:3968
    ds_read_b64_tr_b16 v[48:49], v23 offset:15424
    ds_read_b64_tr_b16 v[50:51], v23 offset:16192
    ds_read_b64_tr_b16 v[52:53], v23 offset:15488
    ds_read_b64_tr_b16 v[54:55], v23 offset:16256
    v_mfma_f32_32x32x16_bf16 v[64:79], v[24:27], v[32:35], v[64:79]
    v_mfma_f32_32x32x16_bf16 v[80:95], v[36:39], v[24:27], v[80:95]
    v_mfma_f32_32x32x16_bf16 v[96:111], v[40:43], v[24:27], v[96:111]
    s_waitcnt lgkmcnt(0)
    ds_read_b128 v[24:27], v21
    ds_read_b64_tr_b16 v[32:33], v23 offset:6272
    ds_read_b64_tr_b16 v[34:35], v23 offset:7040
    ds_read_b64_tr_b16 v[36:37], v23 offset:18496
    ds_read_b64_tr_b16 v[38:39], v23 offset:19264
    ds_read_b64_tr_b16 v[40:41], v23 offset:18560
    ds_read_b64_tr_b16 v[42:43], v23 offset:19328
    v_mfma_f32_32x32x16_bf16 v[64:79], v[28:31], v[44:47], v[64:79]
    v_mfma_f32_32x32x16_bf16 v[80:95], v[48:51], v[28:31], v[80:95]
    v_mfma_f32_32x32x16_bf16 v[96:111], v[52:55], v[28:31], v[96:111]
    s_waitcnt lgkmcnt(0)
    ds_read_b128 v[28:31], v22
    ds_read_b64_tr_b16 v[44:45], v23 offset:9344
    ds_read_b64_tr_b16 v[46:47], v23 offset:10112
    ds_read_b64_tr_b16 v[48:49], v23 offset:21568
    ds_read_b64_tr_b16 v[50:51], v23 offset:22336
    ds_read_b64_tr_b16 v[52:53], v23 offset:21632
    ds_read_b64_tr_b16 v[54:55], v23 offset:22400
    v_mfma_f32_32x32x16_bf16 v[64:79], v[24:27], v[32:35], v[64:79]
    v_mfma_f32_32x32x16_bf16 v[80:95], v[36:39], v[24:27], v[80:95]
    v_mfma_f32_32x32x16_bf16 v[96:111], v[40:43], v[24:27], v[96:111]
    s_waitcnt lgkmcnt(0)
    s_barrier
    v_add_u32 v19, 81920, v14
    v_add_u32 v20, 81920, v15
    v_add_u32 v21, 81920, v16
    v_add_u32 v22, 81920, v17
    v_add_u32 v23, 98304, v18
    ds_read_b128 v[24:27], v19
    ds_read_b64_tr_b16 v[32:33], v23 offset:128
    ds_read_b64_tr_b16 v[34:35], v23 offset:896
    ds_read_b64_tr_b16 v[36:37], v23 offset:12352
    ds_read_b64_tr_b16 v[38:39], v23 offset:13120
    ds_read_b64_tr_b16 v[40:41], v23 offset:12416
    ds_read_b64_tr_b16 v[42:43], v23 offset:13184
    v_mfma_f32_32x32x16_bf16 v[64:79], v[28:31], v[44:47], v[64:79]
    v_mfma_f32_32x32x16_bf16 v[80:95], v[48:51], v[28:31], v[80:95]
    v_mfma_f32_32x32x16_bf16 v[96:111], v[52:55], v[28:31], v[96:111]
    s_waitcnt lgkmcnt(0)
    ds_read_b128 v[28:31], v20
    ds_read_b64_tr_b16 v[44:45], v23 offset:3200
    ds_read_b64_tr_b16 v[46:47], v23 offset:3968
    ds_read_b64_tr_b16 v[48:49], v23 offset:15424
    ds_read_b64_tr_b16 v[50:51], v23 offset:16192
    ds_read_b64_tr_b16 v[52:53], v23 offset:15488
    ds_read_b64_tr_b16 v[54:55], v23 offset:16256
    v_mfma_f32_32x32x16_bf16 v[64:79], v[24:27], v[32:35], v[64:79]
    v_mfma_f32_32x32x16_bf16 v[80:95], v[36:39], v[24:27], v[80:95]
    v_mfma_f32_32x32x16_bf16 v[96:111], v[40:43], v[24:27], v[96:111]
    s_waitcnt lgkmcnt(0)
    ds_read_b128 v[24:27], v21
    ds_read_b64_tr_b16 v[32:33], v23 offset:6272
    ds_read_b64_tr_b16 v[34:35], v23 offset:7040
    ds_read_b64_tr_b16 v[36:37], v23 offset:18496
    ds_read_b64_tr_b16 v[38:39], v23 offset:19264
    ds_read_b64_tr_b16 v[40:41], v23 offset:18560
    ds_read_b64_tr_b16 v[42:43], v23 offset:19328
    v_mfma_f32_32x32x16_bf16 v[64:79], v[28:31], v[44:47], v[64:79]
    v_mfma_f32_32x32x16_bf16 v[80:95], v[48:51], v[28:31], v[80:95]
    v_mfma_f32_32x32x16_bf16 v[96:111], v[52:55], v[28:31], v[96:111]
    s_waitcnt lgkmcnt(0)
    ds_read_b128 v[28:31], v22
    ds_read_b64_tr_b16 v[44:45], v23 offset:9344
    ds_read_b64_tr_b16 v[46:47], v23 offset:10112
    ds_read_b64_tr_b16 v[48:49], v23 offset:21568
    ds_read_b64_tr_b16 v[50:51], v23 offset:22336
    ds_read_b64_tr_b16 v[52:53], v23 offset:21632
    ds_read_b64_tr_b16 v[54:55], v23 offset:22400
    v_mfma_f32_32x32x16_bf16 v[64:79], v[24:27], v[32:35], v[64:79]
    v_mfma_f32_32x32x16_bf16 v[80:95], v[36:39], v[24:27], v[80:95]
    v_mfma_f32_32x32x16_bf16 v[96:111], v[40:43], v[24:27], v[96:111]
    s_waitcnt lgkmcnt(0)
    s_barrier
    v_add_u32 v19, 0, v14
    v_add_u32 v20, 0, v15
    v_add_u32 v21, 0, v16
    v_add_u32 v22, 0, v17
    v_add_u32 v23, 16384, v18
    ds_read_b128 v[24:27], v19
    ds_read_b64_tr_b16 v[32:33], v23 offset:128
    ds_read_b64_tr_b16 v[34:35], v23 offset:896
    ds_read_b64_tr_b16 v[36:37], v23 offset:12352
    ds_read_b64_tr_b16 v[38:39], v23 offset:13120
    ds_read_b64_tr_b16 v[40:41], v23 offset:12416
    ds_read_b64_tr_b16 v[42:43], v23 offset:13184
    v_mfma_f32_32x32x16_bf16 v[64:79], v[28:31], v[44:47], v[64:79]
    v_mfma_f32_32x32x16_bf16 v[80:95], v[48:51], v[28:31], v[80:95]
    v_mfma_f32_32x32x16_bf16 v[96:111], v[52:55], v[28:31], v[96:111]
    s_waitcnt lgkmcnt(0)
    ds_read_b128 v[28:31], v20
    ds_read_b64_tr_b16 v[44:45], v23 offset:3200
    ds_read_b64_tr_b16 v[46:47], v23 offset:3968
    ds_read_b64_tr_b16 v[48:49], v23 offset:15424
    ds_read_b64_tr_b16 v[50:51], v23 offset:16192
    ds_read_b64_tr_b16 v[52:53], v23 offset:15488
    ds_read_b64_tr_b16 v[54:55], v23 offset:16256
    v_mfma_f32_32x32x16_bf16 v[64:79], v[24:27], v[32:35], v[64:79]
    v_mfma_f32_32x32x16_bf16 v[80:95], v[36:39], v[24:27], v[80:95]
    v_mfma_f32_32x32x16_bf16 v[96:111], v[40:43], v[24:27], v[96:111]
    s_waitcnt lgkmcnt(0)
    ds_read_b128 v[24:27], v21
    ds_read_b64_tr_b16 v[32:33], v23 offset:6272
    ds_read_b64_tr_b16 v[34:35], v23 offset:7040
    ds_read_b64_tr_b16 v[36:37], v23 offset:18496
    ds_read_b64_tr_b16 v[38:39], v23 offset:19264
    ds_read_b64_tr_b16 v[40:41], v23 offset:18560
    ds_read_b64_tr_b16 v[42:43], v23 offset:19328
    v_mfma_f32_32x32x16_bf16 v[64:79], v[28:31], v[44:47], v[64:79]
    v_mfma_f32_32x32x16_bf16 v[80:95], v[48:51], v[28:31], v[80:95]
    v_mfma_f32_32x32x16_bf16 v[96:111], v[52:55], v[28:31], v[96:111]
    s_waitcnt lgkmcnt(0)
    ds_read_b128 v[28:31], v22
    ds_read_b64_tr_b16 v[44:45], v23 offset:9344
    ds_read_b64_tr_b16 v[46:47], v23 offset:10112
    ds_read_b64_tr_b16 v[48:49], v23 offset:21568
    ds_read_b64_tr_b16 v[50:51], v23 offset:22336
    ds_read_b64_tr_b16 v[52:53], v23 offset:21632
    ds_read_b64_tr_b16 v[54:55], v23 offset:22400
    v_mfma_f32_32x32x16_bf16 v[64:79], v[24:27], v[32:35], v[64:79]
    v_mfma_f32_32x32x16_bf16 v[80:95], v[36:39], v[24:27], v[80:95]
    v_mfma_f32_32x32x16_bf16 v[96:111], v[40:43], v[24:27], v[96:111]
    s_waitcnt lgkmcnt(0)
    s_barrier
    v_add_u32 v19, 40960, v14
    v_add_u32 v20, 40960, v15
    v_add_u32 v21, 40960, v16
    v_add_u32 v22, 40960, v17
    v_add_u32 v23, 57344, v18
    ds_read_b128 v[24:27], v19
    ds_read_b64_tr_b16 v[32:33], v23 offset:128
    ds_read_b64_tr_b16 v[34:35], v23 offset:896
    ds_read_b64_tr_b16 v[36:37], v23 offset:12352
    ds_read_b64_tr_b16 v[38:39], v23 offset:13120
    ds_read_b64_tr_b16 v[40:41], v23 offset:12416
    ds_read_b64_tr_b16 v[42:43], v23 offset:13184
    v_mfma_f32_32x32x16_bf16 v[64:79], v[28:31], v[44:47], v[64:79]
    v_mfma_f32_32x32x16_bf16 v[80:95], v[48:51], v[28:31], v[80:95]
    v_mfma_f32_32x32x16_bf16 v[96:111], v[52:55], v[28:31], v[96:111]
    s_waitcnt lgkmcnt(0)
    ds_read_b128 v[28:31], v20
    ds_read_b64_tr_b16 v[44:45], v23 offset:3200
    ds_read_b64_tr_b16 v[46:47], v23 offset:3968
    ds_read_b64_tr_b16 v[48:49], v23 offset:15424
    ds_read_b64_tr_b16 v[50:51], v23 offset:16192
    ds_read_b64_tr_b16 v[52:53], v23 offset:15488
    ds_read_b64_tr_b16 v[54:55], v23 offset:16256
    v_mfma_f32_32x32x16_bf16 v[64:79], v[24:27], v[32:35], v[64:79]
    v_mfma_f32_32x32x16_bf16 v[80:95], v[36:39], v[24:27], v[80:95]
    v_mfma_f32_32x32x16_bf16 v[96:111], v[40:43], v[24:27], v[96:111]
    s_waitcnt lgkmcnt(0)
    ds_read_b128 v[24:27], v21
    ds_read_b64_tr_b16 v[32:33], v23 offset:6272
    ds_read_b64_tr_b16 v[34:35], v23 offset:7040
    ds_read_b64_tr_b16 v[36:37], v23 offset:18496
    ds_read_b64_tr_b16 v[38:39], v23 offset:19264
    ds_read_b64_tr_b16 v[40:41], v23 offset:18560
    ds_read_b64_tr_b16 v[42:43], v23 offset:19328
    v_mfma_f32_32x32x16_bf16 v[64:79], v[28:31], v[44:47], v[64:79]
    v_mfma_f32_32x32x16_bf16 v[80:95], v[48:51], v[28:31], v[80:95]
    v_mfma_f32_32x32x16_bf16 v[96:111], v[52:55], v[28:31], v[96:111]
    s_waitcnt lgkmcnt(0)
    ds_read_b128 v[28:31], v22
    ds_read_b64_tr_b16 v[44:45], v23 offset:9344
    ds_read_b64_tr_b16 v[46:47], v23 offset:10112
    ds_read_b64_tr_b16 v[48:49], v23 offset:21568
    ds_read_b64_tr_b16 v[50:51], v23 offset:22336
    ds_read_b64_tr_b16 v[52:53], v23 offset:21632
    ds_read_b64_tr_b16 v[54:55], v23 offset:22400
    v_mfma_f32_32x32x16_bf16 v[64:79], v[24:27], v[32:35], v[64:79]
    v_mfma_f32_32x32x16_bf16 v[80:95], v[36:39], v[24:27], v[80:95]
    v_mfma_f32_32x32x16_bf16 v[96:111], v[40:43], v[24:27], v[96:111]
    s_waitcnt lgkmcnt(0)
    s_barrier
    v_add_u32 v19, 81920, v14
    v_add_u32 v20, 81920, v15
    v_add_u32 v21, 81920, v16
    v_add_u32 v22, 81920, v17
    v_add_u32 v23, 98304, v18
    ds_read_b128 v[24:27], v19
    ds_read_b64_tr_b16 v[32:33], v23 offset:128
    ds_read_b64_tr_b16 v[34:35], v23 offset:896
    ds_read_b64_tr_b16 v[36:37], v23 offset:12352
    ds_read_b64_tr_b16 v[38:39], v23 offset:13120
    ds_read_b64_tr_b16 v[40:41], v23 offset:12416
    ds_read_b64_tr_b16 v[42:43], v23 offset:13184
    v_mfma_f32_32x32x16_bf16 v[64:79], v[28:31], v[44:47], v[64:79]
    v_mfma_f32_32x32x16_bf16 v[80:95], v[48:51], v[28:31], v[80:95]
    v_mfma_f32_32x32x16_bf16 v[96:111], v[52:55], v[28:31], v[96:111]
    s_waitcnt lgkmcnt(0)
    ds_read_b128 v[28:31], v20
    ds_read_b64_tr_b16 v[44:45], v23 offset:3200
    ds_read_b64_tr_b16 v[46:47], v23 offset:3968
    ds_read_b64_tr_b16 v[48:49], v23 offset:15424
    ds_read_b64_tr_b16 v[50:51], v23 offset:16192
    ds_read_b64_tr_b16 v[52:53], v23 offset:15488
    ds_read_b64_tr_b16 v[54:55], v23 offset:16256
    v_mfma_f32_32x32x16_bf16 v[64:79], v[24:27], v[32:35], v[64:79]
    v_mfma_f32_32x32x16_bf16 v[80:95], v[36:39], v[24:27], v[80:95]
    v_mfma_f32_32x32x16_bf16 v[96:111], v[40:43], v[24:27], v[96:111]
    s_waitcnt lgkmcnt(0)
    ds_read_b128 v[24:27], v21
    ds_read_b64_tr_b16 v[32:33], v23 offset:6272
    ds_read_b64_tr_b16 v[34:35], v23 offset:7040
    ds_read_b64_tr_b16 v[36:37], v23 offset:18496
    ds_read_b64_tr_b16 v[38:39], v23 offset:19264
    ds_read_b64_tr_b16 v[40:41], v23 offset:18560
    ds_read_b64_tr_b16 v[42:43], v23 offset:19328
    v_mfma_f32_32x32x16_bf16 v[64:79], v[28:31], v[44:47], v[64:79]
    v_mfma_f32_32x32x16_bf16 v[80:95], v[48:51], v[28:31], v[80:95]
    v_mfma_f32_32x32x16_bf16 v[96:111], v[52:55], v[28:31], v[96:111]
    s_waitcnt lgkmcnt(0)
    ds_read_b128 v[28:31], v22
    ds_read_b64_tr_b16 v[44:45], v23 offset:9344
    ds_read_b64_tr_b16 v[46:47], v23 offset:10112
    ds_read_b64_tr_b16 v[48:49], v23 offset:21568
    ds_read_b64_tr_b16 v[50:51], v23 offset:22336
    ds_read_b64_tr_b16 v[52:53], v23 offset:21632
    ds_read_b64_tr_b16 v[54:55], v23 offset:22400
    v_mfma_f32_32x32x16_bf16 v[64:79], v[24:27], v[32:35], v[64:79]
    v_mfma_f32_32x32x16_bf16 v[80:95], v[36:39], v[24:27], v[80:95]
    v_mfma_f32_32x32x16_bf16 v[96:111], v[40:43], v[24:27], v[96:111]
    s_waitcnt lgkmcnt(0)
    s_barrier
    v_add_u32 v19, 0, v14
    v_add_u32 v20, 0, v15
    v_add_u32 v21, 0, v16
    v_add_u32 v22, 0, v17
    v_add_u32 v23, 16384, v18
    ds_read_b128 v[24:27], v19
    ds_read_b64_tr_b16 v[32:33], v23 offset:128
    ds_read_b64_tr_b16 v[34:35], v23 offset:896
    ds_read_b64_tr_b16 v[36:37], v23 offset:12352
    ds_read_b64_tr_b16 v[38:39], v23 offset:13120
    ds_read_b64_tr_b16 v[40:41], v23 offset:12416
    ds_read_b64_tr_b16 v[42:43], v23 offset:13184
    v_mfma_f32_32x32x16_bf16 v[64:79], v[28:31], v[44:47], v[64:79]
    v_mfma_f32_32x32x16_bf16 v[80:95], v[48:51], v[28:31], v[80:95]
    v_mfma_f32_32x32x16_bf16 v[96:111], v[52:55], v[28:31], v[96:111]
    s_waitcnt lgkmcnt(0)
    ds_read_b128 v[28:31], v20
    ds_read_b64_tr_b16 v[44:45], v23 offset:3200
    ds_read_b64_tr_b16 v[46:47], v23 offset:3968
    ds_read_b64_tr_b16 v[48:49], v23 offset:15424
    ds_read_b64_tr_b16 v[50:51], v23 offset:16192
    ds_read_b64_tr_b16 v[52:53], v23 offset:15488
    ds_read_b64_tr_b16 v[54:55], v23 offset:16256
    v_mfma_f32_32x32x16_bf16 v[64:79], v[24:27], v[32:35], v[64:79]
    v_mfma_f32_32x32x16_bf16 v[80:95], v[36:39], v[24:27], v[80:95]
    v_mfma_f32_32x32x16_bf16 v[96:111], v[40:43], v[24:27], v[96:111]
    s_waitcnt lgkmcnt(0)
    ds_read_b128 v[24:27], v21
    ds_read_b64_tr_b16 v[32:33], v23 offset:6272
    ds_read_b64_tr_b16 v[34:35], v23 offset:7040
    ds_read_b64_tr_b16 v[36:37], v23 offset:18496
    ds_read_b64_tr_b16 v[38:39], v23 offset:19264
    ds_read_b64_tr_b16 v[40:41], v23 offset:18560
    ds_read_b64_tr_b16 v[42:43], v23 offset:19328
    v_mfma_f32_32x32x16_bf16 v[64:79], v[28:31], v[44:47], v[64:79]
    v_mfma_f32_32x32x16_bf16 v[80:95], v[48:51], v[28:31], v[80:95]
    v_mfma_f32_32x32x16_bf16 v[96:111], v[52:55], v[28:31], v[96:111]
    s_waitcnt lgkmcnt(0)
    ds_read_b128 v[28:31], v22
    ds_read_b64_tr_b16 v[44:45], v23 offset:9344
    ds_read_b64_tr_b16 v[46:47], v23 offset:10112
    ds_read_b64_tr_b16 v[48:49], v23 offset:21568
    ds_read_b64_tr_b16 v[50:51], v23 offset:22336
    ds_read_b64_tr_b16 v[52:53], v23 offset:21632
    ds_read_b64_tr_b16 v[54:55], v23 offset:22400
    v_mfma_f32_32x32x16_bf16 v[64:79], v[24:27], v[32:35], v[64:79]
    v_mfma_f32_32x32x16_bf16 v[80:95], v[36:39], v[24:27], v[80:95]
    v_mfma_f32_32x32x16_bf16 v[96:111], v[40:43], v[24:27], v[96:111]
    s_waitcnt lgkmcnt(0)
    s_barrier
    v_add_u32 v19, 40960, v14
    v_add_u32 v20, 40960, v15
    v_add_u32 v21, 40960, v16
    v_add_u32 v22, 40960, v17
    v_add_u32 v23, 57344, v18
    ds_read_b128 v[24:27], v19
    ds_read_b64_tr_b16 v[32:33], v23 offset:128
    ds_read_b64_tr_b16 v[34:35], v23 offset:896
    ds_read_b64_tr_b16 v[36:37], v23 offset:12352
    ds_read_b64_tr_b16 v[38:39], v23 offset:13120
    ds_read_b64_tr_b16 v[40:41], v23 offset:12416
    ds_read_b64_tr_b16 v[42:43], v23 offset:13184
    v_mfma_f32_32x32x16_bf16 v[64:79], v[28:31], v[44:47], v[64:79]
    v_mfma_f32_32x32x16_bf16 v[80:95], v[48:51], v[28:31], v[80:95]
    v_mfma_f32_32x32x16_bf16 v[96:111], v[52:55], v[28:31], v[96:111]
    s_waitcnt lgkmcnt(0)
    ds_read_b128 v[28:31], v20
    ds_read_b64_tr_b16 v[44:45], v23 offset:3200
    ds_read_b64_tr_b16 v[46:47], v23 offset:3968
    ds_read_b64_tr_b16 v[48:49], v23 offset:15424
    ds_read_b64_tr_b16 v[50:51], v23 offset:16192
    ds_read_b64_tr_b16 v[52:53], v23 offset:15488
    ds_read_b64_tr_b16 v[54:55], v23 offset:16256
    v_mfma_f32_32x32x16_bf16 v[64:79], v[24:27], v[32:35], v[64:79]
    v_mfma_f32_32x32x16_bf16 v[80:95], v[36:39], v[24:27], v[80:95]
    v_mfma_f32_32x32x16_bf16 v[96:111], v[40:43], v[24:27], v[96:111]
    s_waitcnt lgkmcnt(0)
    ds_read_b128 v[24:27], v21
    ds_read_b64_tr_b16 v[32:33], v23 offset:6272
    ds_read_b64_tr_b16 v[34:35], v23 offset:7040
    ds_read_b64_tr_b16 v[36:37], v23 offset:18496
    ds_read_b64_tr_b16 v[38:39], v23 offset:19264
    ds_read_b64_tr_b16 v[40:41], v23 offset:18560
    ds_read_b64_tr_b16 v[42:43], v23 offset:19328
    v_mfma_f32_32x32x16_bf16 v[64:79], v[28:31], v[44:47], v[64:79]
    v_mfma_f32_32x32x16_bf16 v[80:95], v[48:51], v[28:31], v[80:95]
    v_mfma_f32_32x32x16_bf16 v[96:111], v[52:55], v[28:31], v[96:111]
    s_waitcnt lgkmcnt(0)
    ds_read_b128 v[28:31], v22
    ds_read_b64_tr_b16 v[44:45], v23 offset:9344
    ds_read_b64_tr_b16 v[46:47], v23 offset:10112
    ds_read_b64_tr_b16 v[48:49], v23 offset:21568
    ds_read_b64_tr_b16 v[50:51], v23 offset:22336
    ds_read_b64_tr_b16 v[52:53], v23 offset:21632
    ds_read_b64_tr_b16 v[54:55], v23 offset:22400
    v_mfma_f32_32x32x16_bf16 v[64:79], v[24:27], v[32:35], v[64:79]
    v_mfma_f32_32x32x16_bf16 v[80:95], v[36:39], v[24:27], v[80:95]
    v_mfma_f32_32x32x16_bf16 v[96:111], v[40:43], v[24:27], v[96:111]
    s_waitcnt lgkmcnt(0)
    v_mfma_f32_32x32x16_bf16 v[64:79], v[28:31], v[44:47], v[64:79]
    v_mfma_f32_32x32x16_bf16 v[80:95], v[48:51], v[28:31], v[80:95]
    v_mfma_f32_32x32x16_bf16 v[96:111], v[52:55], v[28:31], v[96:111]
    v_and_b32 v26, 31, v1
    v_lshrrev_b32 v27, 5, v1
    s_lshl_b32 s44, s36, 2
    s_add_u32 s46, s44, s40
    v_lshlrev_b32 v24, 4, v1
    s_waitcnt vmcnt(0)
    s_nop 7
    v_lshrrev_b32 v25, 4, v26
    v_lshlrev_b32 v25, 16, v25
    v_lshl_add_u32 v25, v27, 8, v25
    v_and_b32 v2, 15, v26
    v_lshl_add_u32 v25, v2, 4, v25
    v_cvt_pk_bf16_f32 v28, v64, v65
    v_cvt_pk_bf16_f32 v29, v66, v67
    v_cvt_pk_bf16_f32 v30, v68, v69
    v_cvt_pk_bf16_f32 v31, v70, v71
    v_cvt_pk_bf16_f32 v32, v72, v73
    v_cvt_pk_bf16_f32 v33, v74, v75
    v_cvt_pk_bf16_f32 v34, v76, v77
    v_cvt_pk_bf16_f32 v35, v78, v79
    s_lshl_b32 s47, s37, 17
    s_lshl_b32 s48, s46, 10
    s_add_u32 s47, s47, s48
    s_add_u32 s47, s47, 4194304
    buffer_store_dwordx4 v[28:31], v25, s[32:35], s47 offen sc1
    buffer_store_dwordx4 v[32:35], v25, s[32:35], s47 offen offset:512 sc1
    s_nop 1
    s_add_u32 s47, s39, 32
    v_lshlrev_b32 v48, 16, v128
    v_and_b32 v49, 0xffff0000, v128
    v_lshlrev_b32 v50, 16, v129
    v_and_b32 v51, 0xffff0000, v129
    v_lshlrev_b32 v52, 16, v130
    v_and_b32 v53, 0xffff0000, v130
    v_lshlrev_b32 v54, 16, v131
    v_and_b32 v55, 0xffff0000, v131
    v_lshlrev_b32 v56, 16, v132
    v_and_b32 v57, 0xffff0000, v132
    v_lshlrev_b32 v58, 16, v133
    v_and_b32 v59, 0xffff0000, v133
    v_lshlrev_b32 v60, 16, v134
    v_and_b32 v61, 0xffff0000, v134
    v_lshlrev_b32 v62, 16, v135
    v_and_b32 v63, 0xffff0000, v135
    v_add_f32 v80, v80, v48
    v_add_f32 v81, v81, v49
    v_add_f32 v82, v82, v50
    v_add_f32 v83, v83, v51
    v_add_f32 v84, v84, v52
    v_add_f32 v85, v85, v53
    v_add_f32 v86, v86, v54
    v_add_f32 v87, v87, v55
    v_mul_f32 v112, 0x3fb8aa3b, v80
    v_mul_f32 v113, 0x3fb8aa3b, v81
    v_mul_f32 v114, 0x3fb8aa3b, v82
    v_mul_f32 v115, 0x3fb8aa3b, v83
    v_mul_f32 v116, 0x3fb8aa3b, v84
    v_mul_f32 v117, 0x3fb8aa3b, v85
    v_mul_f32 v118, 0x3fb8aa3b, v86
    v_mul_f32 v119, 0x3fb8aa3b, v87
    v_min_f32 v112, 0x41f00000, v112
    v_min_f32 v113, 0x41f00000, v113
    v_min_f32 v114, 0x41f00000, v114
    v_min_f32 v115, 0x41f00000, v115
    v_min_f32 v116, 0x41f00000, v116
    v_min_f32 v117, 0x41f00000, v117
    v_min_f32 v118, 0x41f00000, v118
    v_min_f32 v119, 0x41f00000, v119
    v_exp_f32 v112, v112
    v_exp_f32 v113, v113
    v_exp_f32 v114, v114
    v_exp_f32 v115, v115
    v_exp_f32 v116, v116
    v_exp_f32 v117, v117
    v_exp_f32 v118, v118
    v_exp_f32 v119, v119
    s_nop 0
    v_add_f32 v120, 2.0, v112
    v_add_f32 v121, 2.0, v113
    v_add_f32 v122, 2.0, v114
    v_add_f32 v123, 2.0, v115
    v_add_f32 v124, 2.0, v116
    v_add_f32 v125, 2.0, v117
    v_add_f32 v126, 2.0, v118
    v_add_f32 v127, 2.0, v119
    v_mul_f32 v120, v120, v112
    v_mul_f32 v121, v121, v113
    v_mul_f32 v122, v122, v114
    v_mul_f32 v123, v123, v115
    v_mul_f32 v124, v124, v116
    v_mul_f32 v125, v125, v117
    v_mul_f32 v126, v126, v118
    v_mul_f32 v127, v127, v119
    v_add_f32 v112, 2.0, v120
    v_add_f32 v113, 2.0, v121
    v_add_f32 v114, 2.0, v122
    v_add_f32 v115, 2.0, v123
    v_add_f32 v116, 2.0, v124
    v_add_f32 v117, 2.0, v125
    v_add_f32 v118, 2.0, v126
    v_add_f32 v119, 2.0, v127
    v_rcp_f32 v112, v112
    v_rcp_f32 v113, v113
    v_rcp_f32 v114, v114
    v_rcp_f32 v115, v115
    v_rcp_f32 v116, v116
    v_rcp_f32 v117, v117
    v_rcp_f32 v118, v118
    v_rcp_f32 v119, v119
    s_nop 0
    v_mul_f32 v120, v120, v112
    v_mul_f32 v121, v121, v113
    v_mul_f32 v122, v122, v114
    v_mul_f32 v123, v123, v115
    v_mul_f32 v124, v124, v116
    v_mul_f32 v125, v125, v117
    v_mul_f32 v126, v126, v118
    v_mul_f32 v127, v127, v119
    v_mul_f32 v80, v80, v120
    v_mul_f32 v81, v81, v121
    v_mul_f32 v82, v82, v122
    v_mul_f32 v83, v83, v123
    v_mul_f32 v84, v84, v124
    v_mul_f32 v85, v85, v125
    v_mul_f32 v86, v86, v126
    v_mul_f32 v87, v87, v127
    v_add_f32 v88, v88, v56
    v_add_f32 v89, v89, v57
    v_add_f32 v90, v90, v58
    v_add_f32 v91, v91, v59
    v_add_f32 v92, v92, v60
    v_add_f32 v93, v93, v61
    v_add_f32 v94, v94, v62
    v_add_f32 v95, v95, v63
    v_mul_f32 v112, 0x3fb8aa3b, v88
    v_mul_f32 v113, 0x3fb8aa3b, v89
    v_mul_f32 v114, 0x3fb8aa3b, v90
    v_mul_f32 v115, 0x3fb8aa3b, v91
    v_mul_f32 v116, 0x3fb8aa3b, v92
    v_mul_f32 v117, 0x3fb8aa3b, v93
    v_mul_f32 v118, 0x3fb8aa3b, v94
    v_mul_f32 v119, 0x3fb8aa3b, v95
    v_min_f32 v112, 0x41f00000, v112
    v_min_f32 v113, 0x41f00000, v113
    v_min_f32 v114, 0x41f00000, v114
    v_min_f32 v115, 0x41f00000, v115
    v_min_f32 v116, 0x41f00000, v116
    v_min_f32 v117, 0x41f00000, v117
    v_min_f32 v118, 0x41f00000, v118
    v_min_f32 v119, 0x41f00000, v119
    v_exp_f32 v112, v112
    v_exp_f32 v113, v113
    v_exp_f32 v114, v114
    v_exp_f32 v115, v115
    v_exp_f32 v116, v116
    v_exp_f32 v117, v117
    v_exp_f32 v118, v118
    v_exp_f32 v119, v119
    s_nop 0
    v_add_f32 v120, 2.0, v112
    v_add_f32 v121, 2.0, v113
    v_add_f32 v122, 2.0, v114
    v_add_f32 v123, 2.0, v115
    v_add_f32 v124, 2.0, v116
    v_add_f32 v125, 2.0, v117
    v_add_f32 v126, 2.0, v118
    v_add_f32 v127, 2.0, v119
    v_mul_f32 v120, v120, v112
    v_mul_f32 v121, v121, v113
    v_mul_f32 v122, v122, v114
    v_mul_f32 v123, v123, v115
    v_mul_f32 v124, v124, v116
    v_mul_f32 v125, v125, v117
    v_mul_f32 v126, v126, v118
    v_mul_f32 v127, v127, v119
    v_add_f32 v112, 2.0, v120
    v_add_f32 v113, 2.0, v121
    v_add_f32 v114, 2.0, v122
    v_add_f32 v115, 2.0, v123
    v_add_f32 v116, 2.0, v124
    v_add_f32 v117, 2.0, v125
    v_add_f32 v118, 2.0, v126
    v_add_f32 v119, 2.0, v127
    v_rcp_f32 v112, v112
    v_rcp_f32 v113, v113
    v_rcp_f32 v114, v114
    v_rcp_f32 v115, v115
    v_rcp_f32 v116, v116
    v_rcp_f32 v117, v117
    v_rcp_f32 v118, v118
    v_rcp_f32 v119, v119
    s_nop 0
    v_mul_f32 v120, v120, v112
    v_mul_f32 v121, v121, v113
    v_mul_f32 v122, v122, v114
    v_mul_f32 v123, v123, v115
    v_mul_f32 v124, v124, v116
    v_mul_f32 v125, v125, v117
    v_mul_f32 v126, v126, v118
    v_mul_f32 v127, v127, v119
    v_mul_f32 v88, v88, v120
    v_mul_f32 v89, v89, v121
    v_mul_f32 v90, v90, v122
    v_mul_f32 v91, v91, v123
    v_mul_f32 v92, v92, v124
    v_mul_f32 v93, v93, v125
    v_mul_f32 v94, v94, v126
    v_mul_f32 v95, v95, v127
    v_cvt_pk_bf16_f32 v28, v80, v81
    v_cvt_pk_bf16_f32 v29, v82, v83
    v_cvt_pk_bf16_f32 v30, v84, v85
    v_cvt_pk_bf16_f32 v31, v86, v87
    v_cvt_pk_bf16_f32 v32, v88, v89
    v_cvt_pk_bf16_f32 v33, v90, v91
    v_cvt_pk_bf16_f32 v34, v92, v93
    v_cvt_pk_bf16_f32 v35, v94, v95
    s_mul_i32 s48, s46, 86
    s_lshr_b32 s49, s47, 4
    s_add_u32 s48, s48, s49
    s_lshl_b32 s48, s48, 10
    s_add_u32 s48, s48, 6291456
    buffer_store_dwordx4 v[28:31], v24, s[32:35], s48 offen
    buffer_store_dwordx4 v[32:35], v24, s[32:35], s48 offen offset:1024
    s_nop 1
    s_cmp_ge_u32 s37, 11
    s_cbranch_scc1 K1_SKIP2
    s_add_u32 s47, s39, 64
    v_lshlrev_b32 v48, 16, v136
    v_and_b32 v49, 0xffff0000, v136
    v_lshlrev_b32 v50, 16, v137
    v_and_b32 v51, 0xffff0000, v137
    v_lshlrev_b32 v52, 16, v138
    v_and_b32 v53, 0xffff0000, v138
    v_lshlrev_b32 v54, 16, v139
    v_and_b32 v55, 0xffff0000, v139
    v_lshlrev_b32 v56, 16, v140
    v_and_b32 v57, 0xffff0000, v140
    v_lshlrev_b32 v58, 16, v141
    v_and_b32 v59, 0xffff0000, v141
    v_lshlrev_b32 v60, 16, v142
    v_and_b32 v61, 0xffff0000, v142
    v_lshlrev_b32 v62, 16, v143
    v_and_b32 v63, 0xffff0000, v143
    v_add_f32 v96, v96, v48
    v_add_f32 v97, v97, v49
    v_add_f32 v98, v98, v50
    v_add_f32 v99, v99, v51
    v_add_f32 v100, v100, v52
    v_add_f32 v101, v101, v53
    v_add_f32 v102, v102, v54
    v_add_f32 v103, v103, v55
    v_mul_f32 v112, 0x3fb8aa3b, v96
    v_mul_f32 v113, 0x3fb8aa3b, v97
    v_mul_f32 v114, 0x3fb8aa3b, v98
    v_mul_f32 v115, 0x3fb8aa3b, v99
    v_mul_f32 v116, 0x3fb8aa3b, v100
    v_mul_f32 v117, 0x3fb8aa3b, v101
    v_mul_f32 v118, 0x3fb8aa3b, v102
    v_mul_f32 v119, 0x3fb8aa3b, v103
    v_min_f32 v112, 0x41f00000, v112
    v_min_f32 v113, 0x41f00000, v113
    v_min_f32 v114, 0x41f00000, v114
    v_min_f32 v115, 0x41f00000, v115
    v_min_f32 v116, 0x41f00000, v116
    v_min_f32 v117, 0x41f00000, v117
    v_min_f32 v118, 0x41f00000, v118
    v_min_f32 v119, 0x41f00000, v119
    v_exp_f32 v112, v112
    v_exp_f32 v113, v113
    v_exp_f32 v114, v114
    v_exp_f32 v115, v115
    v_exp_f32 v116, v116
    v_exp_f32 v117, v117
    v_exp_f32 v118, v118
    v_exp_f32 v119, v119
    s_nop 0
    v_add_f32 v120, 2.0, v112
    v_add_f32 v121, 2.0, v113
    v_add_f32 v122, 2.0, v114
    v_add_f32 v123, 2.0, v115
    v_add_f32 v124, 2.0, v116
    v_add_f32 v125, 2.0, v117
    v_add_f32 v126, 2.0, v118
    v_add_f32 v127, 2.0, v119
    v_mul_f32 v120, v120, v112
    v_mul_f32 v121, v121, v113
    v_mul_f32 v122, v122, v114
    v_mul_f32 v123, v123, v115
    v_mul_f32 v124, v124, v116
    v_mul_f32 v125, v125, v117
    v_mul_f32 v126, v126, v118
    v_mul_f32 v127, v127, v119
    v_add_f32 v112, 2.0, v120
    v_add_f32 v113, 2.0, v121
    v_add_f32 v114, 2.0, v122
    v_add_f32 v115, 2.0, v123
    v_add_f32 v116, 2.0, v124
    v_add_f32 v117, 2.0, v125
    v_add_f32 v118, 2.0, v126
    v_add_f32 v119, 2.0, v127
    v_rcp_f32 v112, v112
    v_rcp_f32 v113, v113
    v_rcp_f32 v114, v114
    v_rcp_f32 v115, v115
    v_rcp_f32 v116, v116
    v_rcp_f32 v117, v117
    v_rcp_f32 v118, v118
    v_rcp_f32 v119, v119
    s_nop 0
    v_mul_f32 v120, v120, v112
    v_mul_f32 v121, v121, v113
    v_mul_f32 v122, v122, v114
    v_mul_f32 v123, v123, v115
    v_mul_f32 v124, v124, v116
    v_mul_f32 v125, v125, v117
    v_mul_f32 v126, v126, v118
    v_mul_f32 v127, v127, v119
    v_mul_f32 v96, v96, v120
    v_mul_f32 v97, v97, v121
    v_mul_f32 v98, v98, v122
    v_mul_f32 v99, v99, v123
    v_mul_f32 v100, v100, v124
    v_mul_f32 v101, v101, v125
    v_mul_f32 v102, v102, v126
    v_mul_f32 v103, v103, v127
    v_add_f32 v104, v104, v56
    v_add_f32 v105, v105, v57
    v_add_f32 v106, v106, v58
    v_add_f32 v107, v107, v59
    v_add_f32 v108, v108, v60
    v_add_f32 v109, v109, v61
    v_add_f32 v110, v110, v62
    v_add_f32 v111, v111, v63
    v_mul_f32 v112, 0x3fb8aa3b, v104
    v_mul_f32 v113, 0x3fb8aa3b, v105
    v_mul_f32 v114, 0x3fb8aa3b, v106
    v_mul_f32 v115, 0x3fb8aa3b, v107
    v_mul_f32 v116, 0x3fb8aa3b, v108
    v_mul_f32 v117, 0x3fb8aa3b, v109
    v_mul_f32 v118, 0x3fb8aa3b, v110
    v_mul_f32 v119, 0x3fb8aa3b, v111
    v_min_f32 v112, 0x41f00000, v112
    v_min_f32 v113, 0x41f00000, v113
    v_min_f32 v114, 0x41f00000, v114
    v_min_f32 v115, 0x41f00000, v115
    v_min_f32 v116, 0x41f00000, v116
    v_min_f32 v117, 0x41f00000, v117
    v_min_f32 v118, 0x41f00000, v118
    v_min_f32 v119, 0x41f00000, v119
    v_exp_f32 v112, v112
    v_exp_f32 v113, v113
    v_exp_f32 v114, v114
    v_exp_f32 v115, v115
    v_exp_f32 v116, v116
    v_exp_f32 v117, v117
    v_exp_f32 v118, v118
    v_exp_f32 v119, v119
    s_nop 0
    v_add_f32 v120, 2.0, v112
    v_add_f32 v121, 2.0, v113
    v_add_f32 v122, 2.0, v114
    v_add_f32 v123, 2.0, v115
    v_add_f32 v124, 2.0, v116
    v_add_f32 v125, 2.0, v117
    v_add_f32 v126, 2.0, v118
    v_add_f32 v127, 2.0, v119
    v_mul_f32 v120, v120, v112
    v_mul_f32 v121, v121, v113
    v_mul_f32 v122, v122, v114
    v_mul_f32 v123, v123, v115
    v_mul_f32 v124, v124, v116
    v_mul_f32 v125, v125, v117
    v_mul_f32 v126, v126, v118
    v_mul_f32 v127, v127, v119
    v_add_f32 v112, 2.0, v120
    v_add_f32 v113, 2.0, v121
    v_add_f32 v114, 2.0, v122
    v_add_f32 v115, 2.0, v123
    v_add_f32 v116, 2.0, v124
    v_add_f32 v117, 2.0, v125
    v_add_f32 v118, 2.0, v126
    v_add_f32 v119, 2.0, v127
    v_rcp_f32 v112, v112
    v_rcp_f32 v113, v113
    v_rcp_f32 v114, v114
    v_rcp_f32 v115, v115
    v_rcp_f32 v116, v116
    v_rcp_f32 v117, v117
    v_rcp_f32 v118, v118
    v_rcp_f32 v119, v119
    s_nop 0
    v_mul_f32 v120, v120, v112
    v_mul_f32 v121, v121, v113
    v_mul_f32 v122, v122, v114
    v_mul_f32 v123, v123, v115
    v_mul_f32 v124, v124, v116
    v_mul_f32 v125, v125, v117
    v_mul_f32 v126, v126, v118
    v_mul_f32 v127, v127, v119
    v_mul_f32 v104, v104, v120
    v_mul_f32 v105, v105, v121
    v_mul_f32 v106, v106, v122
    v_mul_f32 v107, v107, v123
    v_mul_f32 v108, v108, v124
    v_mul_f32 v109, v109, v125
    v_mul_f32 v110, v110, v126
    v_mul_f32 v111, v111, v127
    v_cvt_pk_bf16_f32 v28, v96, v97
    v_cvt_pk_bf16_f32 v29, v98, v99
    v_cvt_pk_bf16_f32 v30, v100, v101
    v_cvt_pk_bf16_f32 v31, v102, v103
    v_cvt_pk_bf16_f32 v32, v104, v105
    v_cvt_pk_bf16_f32 v33, v106, v107
    v_cvt_pk_bf16_f32 v34, v108, v109
    v_cvt_pk_bf16_f32 v35, v110, v111
    s_mul_i32 s48, s46, 86
    s_lshr_b32 s49, s47, 4
    s_add_u32 s48, s48, s49
    s_lshl_b32 s48, s48, 10
    s_add_u32 s48, s48, 6291456
    buffer_store_dwordx4 v[28:31], v24, s[32:35], s48 offen
    buffer_store_dwordx4 v[32:35], v24, s[32:35], s48 offen offset:1024
    s_nop 1
K1_SKIP2:
    s_endpgm
.section .rodata,"a"
.p2align 6
.amdhsa_kernel proj_kernel
  .amdhsa_next_free_vgpr 144
  .amdhsa_next_free_sgpr 102
  .amdhsa_accum_offset 144
  .amdhsa_group_segment_fixed_size 0
  .amdhsa_kernarg_size 88
  .amdhsa_user_sgpr_count 2
  .amdhsa_user_sgpr_kernarg_segment_ptr 1
  .amdhsa_system_sgpr_workgroup_id_x 1
.end_amdhsa_kernel
.text
.globl attn_kernel
.p2align 8
.type attn_kernel,@function
attn_kernel:
    s_cmp_ge_u32 s2, 256
    s_cbranch_scc1 K2_END
    s_load_dwordx2 s[12:13], s[0:1], 80
    s_and_b32 s44, s2, 7
    s_lshr_b32 s45, s2, 3
    s_lshl_b32 s44, s44, 2
    s_and_b32 s46, s45, 3
    s_add_u32 s20, s44, s46
    s_lshr_b32 s21, s45, 2
    v_and_b32 v1, 63, v0
    v_lshrrev_b32 v2, 6, v0
    s_nop 0
    v_readfirstlane_b32 s22, v2
    s_waitcnt lgkmcnt(0)
    s_mov_b32 s16, s12
    s_and_b32 s17, s13, 0xffff
    s_mov_b32 s18, 268435456
    s_mov_b32 s19, 0x00020000
    v_lshlrev_b32 v5, 4, v1
    s_lshl_b32 s44, s20, 16
    s_cmp_lt_u32 s22, 8
    s_cbranch_scc1 K2_ATT
    s_sub_u32 s23, s22, 8
    v_mov_b32 v6, 131072
    v_mov_b32 v7, 1
    s_lshl_b32 s45, s23, 10
    s_add_u32 s46, s44, s45
    s_add_u32 m0, s45, 0
    s_add_u32 s47, s46, 2097152
    buffer_load_dwordx4 v5, s[16:19], s47 offen lds
    s_add_u32 m0, s45, 65536
    s_add_u32 s47, s46, 4194304
    buffer_load_dwordx4 v5, s[16:19], s47 offen lds
    v_mov_b32 v3, 0
    v_lshl_add_u32 v2, v1, 2, v6
    ds_write_b32 v2, v3
    s_add_u32 m0, s45, 4096
    s_add_u32 s47, s46, 2101248
    buffer_load_dwordx4 v5, s[16:19], s47 offen lds
    s_add_u32 m0, s45, 8192
    s_add_u32 s47, s46, 2105344
    buffer_load_dwordx4 v5, s[16:19], s47 offen lds
    s_add_u32 m0, s45, 12288
    s_add_u32 s47, s46, 2109440
    buffer_load_dwordx4 v5, s[16:19], s47 offen lds
    s_add_u32 m0, s45, 69632
    s_add_u32 s47, s46, 4198400
    buffer_load_dwordx4 v5, s[16:19], s47 offen lds
    s_add_u32 m0, s45, 73728
    s_add_u32 s47, s46, 4202496
    buffer_load_dwordx4 v5, s[16:19], s47 offen lds
    s_add_u32 m0, s45, 77824
    s_add_u32 s47, s46, 4206592
    buffer_load_dwordx4 v5, s[16:19], s47 offen lds
    s_waitcnt lgkmcnt(0)
    s_barrier
    s_waitcnt vmcnt(6)
    s_mov_b64 exec, 1
    ds_add_u32 v6, v7 offset:0
    s_mov_b64 exec, -1
    s_add_u32 m0, s45, 16384
    s_add_u32 s47, s46, 2113536
    buffer_load_dwordx4 v5, s[16:19], s47 offen lds
    s_add_u32 m0, s45, 20480
    s_add_u32 s47, s46, 2117632
    buffer_load_dwordx4 v5, s[16:19], s47 offen lds
    s_add_u32 m0, s45, 24576
    s_add_u32 s47, s46, 2121728
    buffer_load_dwordx4 v5, s[16:19], s47 offen lds
    s_add_u32 m0, s45, 28672
    s_add_u32 s47, s46, 2125824
    buffer_load_dwordx4 v5, s[16:19], s47 offen lds
    s_add_u32 m0, s45, 81920
    s_add_u32 s47, s46, 4210688
    buffer_load_dwordx4 v5, s[16:19], s47 offen lds
    s_add_u32 m0, s45, 86016
    s_add_u32 s47, s46, 4214784
    buffer_load_dwordx4 v5, s[16:19], s47 offen lds
    s_add_u32 m0, s45, 90112
    s_add_u32 s47, s46, 4218880
    buffer_load_dwordx4 v5, s[16:19], s47 offen lds
    s_add_u32 m0, s45, 94208
    s_add_u32 s47, s46, 4222976
    buffer_load_dwordx4 v5, s[16:19], s47 offen lds
    s_waitcnt vmcnt(8)
    s_mov_b64 exec, 1
    ds_add_u32 v6, v7 offset:4
    s_mov_b64 exec, -1
    s_add_u32 m0, s45, 32768
    s_add_u32 s47, s46, 2129920
    buffer_load_dwordx4 v5, s[16:19], s47 offen lds
    s_add_u32 m0, s45, 36864
    s_add_u32 s47, s46, 2134016
    buffer_load_dwordx4 v5, s[16:19], s47 offen lds
    s_add_u32 m0, s45, 40960
    s_add_u32 s47, s46, 2138112
    buffer_load_dwordx4 v5, s[16:19], s47 offen lds
    s_add_u32 m0, s45, 45056
    s_add_u32 s47, s46, 2142208
    buffer_load_dwordx4 v5, s[16:19], s47 offen lds
    s_add_u32 m0, s45, 98304
    s_add_u32 s47, s46, 4227072
    buffer_load_dwordx4 v5, s[16:19], s47 offen lds
    s_add_u32 m0, s45, 102400
    s_add_u32 s47, s46, 4231168
    buffer_load_dwordx4 v5, s[16:19], s47 offen lds
    s_add_u32 m0, s45, 106496
    s_add_u32 s47, s46, 4235264
    buffer_load_dwordx4 v5, s[16:19], s47 offen lds
    s_add_u32 m0, s45, 110592
    s_add_u32 s47, s46, 4239360
    buffer_load_dwordx4 v5, s[16:19], s47 offen lds
    s_waitcnt vmcnt(8)
    s_mov_b64 exec, 1
    ds_add_u32 v6, v7 offset:8
    s_mov_b64 exec, -1
    s_add_u32 m0, s45, 49152
    s_add_u32 s47, s46, 2146304
    buffer_load_dwordx4 v5, s[16:19], s47 offen lds
    s_add_u32 m0, s45, 53248
    s_add_u32 s47, s46, 2150400
    buffer_load_dwordx4 v5, s[16:19], s47 offen lds
    s_add_u32 m0, s45, 57344
    s_add_u32 s47, s46, 2154496
    buffer_load_dwordx4 v5, s[16:19], s47 offen lds
    s_add_u32 m0, s45, 61440
    s_add_u32 s47, s46, 2158592
    buffer_load_dwordx4 v5, s[16:19], s47 offen lds
    s_add_u32 m0, s45, 114688
    s_add_u32 s47, s46, 4243456
    buffer_load_dwordx4 v5, s[16:19], s47 offen lds
    s_add_u32 m0, s45, 118784
    s_add_u32 s47, s46, 4247552
    buffer_load_dwordx4 v5, s[16:19], s47 offen lds
    s_add_u32 m0, s45, 122880
    s_add_u32 s47, s46, 4251648
    buffer_load_dwordx4 v5, s[16:19], s47 offen lds
    s_add_u32 m0, s45, 126976
    s_add_u32 s47, s46, 4255744
    buffer_load_dwordx4 v5, s[16:19], s47 offen lds
    s_waitcnt vmcnt(8)
    s_mov_b64 exec, 1
    ds_add_u32 v6, v7 offset:12
    s_mov_b64 exec, -1
    s_waitcnt vmcnt(0)
    s_mov_b64 exec, 1
    ds_add_u32 v6, v7 offset:16
    s_mov_b64 exec, -1
    s_mul_i32 s47, s23, 21
    s_lshl_b32 s48, s20, 1
    s_mul_i32 s48, s48, 86
    s_add_u32 s48, s48, s47
    s_lshl_b32 s48, s48, 10
    s_add_u32 s27, s48, 6291456
    s_lshl_b32 s48, s47, 4
    s_lshl_b32 s49, s21, 1
    s_add_u32 s48, s48, s49
    s_lshl_b32 s48, s48, 10
    s_add_u32 s28, s48, 20971520
    s_add_u32 s47, s27, 0
    buffer_load_dwordx4 v[8:11], v5, s[16:19], s47 offen
    s_add_u32 s47, s27, 88064
    buffer_load_dwordx4 v[12:15], v5, s[16:19], s47 offen
    s_add_u32 s47, s28, 0
    buffer_load_dwordx4 v[16:19], v5, s[16:19], s47 offen
    buffer_load_dwordx4 v[20:23], v5, s[16:19], s47 offen offset:1024
    s_add_u32 s47, s27, 1024
    buffer_load_dwordx4 v[24:27], v5, s[16:19], s47 offen
    s_add_u32 s47, s27, 89088
    buffer_load_dwordx4 v[28:31], v5, s[16:19], s47 offen
    s_add_u32 s47, s28, 16384
    buffer_load_dwordx4 v[32:35], v5, s[16:19], s47 offen
    buffer_load_dwordx4 v[36:39], v5, s[16:19], s47 offen offset:1024
    s_add_u32 s47, s27, 2048
    buffer_load_dwordx4 v[40:43], v5, s[16:19], s47 offen
    s_add_u32 s47, s27, 90112
    buffer_load_dwordx4 v[44:47], v5, s[16:19], s47 offen
    s_add_u32 s47, s28, 32768
    buffer_load_dwordx4 v[48:51], v5, s[16:19], s47 offen
    buffer_load_dwordx4 v[52:55], v5, s[16:19], s47 offen offset:1024
    s_waitcnt vmcnt(8)
    v_mfma_f32_32x32x16_bf16 v[64:79], v[16:19], v[8:11], 0
    v_mfma_f32_32x32x16_bf16 v[80:95], v[20:23], v[8:11], 0
    v_mfma_f32_32x32x16_bf16 v[96:111], v[16:19], v[12:15], 0
    v_mfma_f32_32x32x16_bf16 v[112:127], v[20:23], v[12:15], 0
    s_add_u32 s47, s27, 3072
    buffer_load_dwordx4 v[8:11], v5, s[16:19], s47 offen
    s_add_u32 s47, s27, 91136
    buffer_load_dwordx4 v[12:15], v5, s[16:19], s47 offen
    s_add_u32 s47, s28, 49152
    buffer_load_dwordx4 v[16:19], v5, s[16:19], s47 offen
    buffer_load_dwordx4 v[20:23], v5, s[16:19], s47 offen offset:1024
    s_waitcnt vmcnt(8)
    v_mfma_f32_32x32x16_bf16 v[64:79], v[32:35], v[24:27], v[64:79]
    v_mfma_f32_32x32x16_bf16 v[80:95], v[36:39], v[24:27], v[80:95]
    v_mfma_f32_32x32x16_bf16 v[96:111], v[32:35], v[28:31], v[96:111]
    v_mfma_f32_32x32x16_bf16 v[112:127], v[36:39], v[28:31], v[112:127]
    s_add_u32 s47, s27, 4096
    buffer_load_dwordx4 v[24:27], v5, s[16:19], s47 offen
    s_add_u32 s47, s27, 92160
    buffer_load_dwordx4 v[28:31], v5, s[16:19], s47 offen
    s_add_u32 s47, s28, 65536
    buffer_load_dwordx4 v[32:35], v5, s[16:19], s47 offen
    buffer_load_dwordx4 v[36:39], v5, s[16:19], s47 offen offset:1024
    s_waitcnt vmcnt(8)
    v_mfma_f32_32x32x16_bf16 v[64:79], v[48:51], v[40:43], v[64:79]
    v_mfma_f32_32x32x16_bf16 v[80:95], v[52:55], v[40:43], v[80:95]
    v_mfma_f32_32x32x16_bf16 v[96:111], v[48:51], v[44:47], v[96:111]
    v_mfma_f32_32x32x16_bf16 v[112:127], v[52:55], v[44:47], v[112:127]
    s_add_u32 s47, s27, 5120
    buffer_load_dwordx4 v[40:43], v5, s[16:19], s47 offen
    s_add_u32 s47, s27, 93184
    buffer_load_dwordx4 v[44:47], v5, s[16:19], s47 offen
    s_add_u32 s47, s28, 81920
    buffer_load_dwordx4 v[48:51], v5, s[16:19], s47 offen
    buffer_load_dwordx4 v[52:55], v5, s[16:19], s47 offen offset:1024
    s_waitcnt vmcnt(8)
    v_mfma_f32_32x32x16_bf16 v[64:79], v[16:19], v[8:11], v[64:79]
    v_mfma_f32_32x32x16_bf16 v[80:95], v[20:23], v[8:11], v[80:95]
    v_mfma_f32_32x32x16_bf16 v[96:111], v[16:19], v[12:15], v[96:111]
    v_mfma_f32_32x32x16_bf16 v[112:127], v[20:23], v[12:15], v[112:127]
    s_add_u32 s47, s27, 6144
    buffer_load_dwordx4 v[8:11], v5, s[16:19], s47 offen
    s_add_u32 s47, s27, 94208
    buffer_load_dwordx4 v[12:15], v5, s[16:19], s47 offen
    s_add_u32 s47, s28, 98304
    buffer_load_dwordx4 v[16:19], v5, s[16:19], s47 offen
    buffer_load_dwordx4 v[20:23], v5, s[16:19], s47 offen offset:1024
    s_waitcnt vmcnt(8)
    v_mfma_f32_32x32x16_bf16 v[64:79], v[32:35], v[24:27], v[64:79]
    v_mfma_f32_32x32x16_bf16 v[80:95], v[36:39], v[24:27], v[80:95]
    v_mfma_f32_32x32x16_bf16 v[96:111], v[32:35], v[28:31], v[96:111]
    v_mfma_f32_32x32x16_bf16 v[112:127], v[36:39], v[28:31], v[112:127]
    s_add_u32 s47, s27, 7168
    buffer_load_dwordx4 v[24:27], v5, s[16:19], s47 offen
    s_add_u32 s47, s27, 95232
    buffer_load_dwordx4 v[28:31], v5, s[16:19], s47 offen
    s_add_u32 s47, s28, 114688
    buffer_load_dwordx4 v[32:35], v5, s[16:19], s47 offen
    buffer_load_dwordx4 v[36:39], v5, s[16:19], s47 offen offset:1024
    s_waitcnt vmcnt(8)
    v_mfma_f32_32x32x16_bf16 v[64:79], v[48:51], v[40:43], v[64:79]
    v_mfma_f32_32x32x16_bf16 v[80:95], v[52:55], v[40:43], v[80:95]
    v_mfma_f32_32x32x16_bf16 v[96:111], v[48:51], v[44:47], v[96:111]
    v_mfma_f32_32x32x16_bf16 v[112:127], v[52:55], v[44:47], v[112:127]
    s_add_u32 s47, s27, 8192
    buffer_load_dwordx4 v[40:43], v5, s[16:19], s47 offen
    s_add_u32 s47, s27, 96256
    buffer_load_dwordx4 v[44:47], v5, s[16:19], s47 offen
    s_add_u32 s47, s28, 131072
    buffer_load_dwordx4 v[48:51], v5, s[16:19], s47 offen
    buffer_load_dwordx4 v[52:55], v5, s[16:19], s47 offen offset:1024
    s_waitcnt vmcnt(8)
    v_mfma_f32_32x32x16_bf16 v[64:79], v[16:19], v[8:11], v[64:79]
    v_mfma_f32_32x32x16_bf16 v[80:95], v[20:23], v[8:11], v[80:95]
    v_mfma_f32_32x32x16_bf16 v[96:111], v[16:19], v[12:15], v[96:111]
    v_mfma_f32_32x32x16_bf16 v[112:127], v[20:23], v[12:15], v[112:127]
    s_add_u32 s47, s27, 9216
    buffer_load_dwordx4 v[8:11], v5, s[16:19], s47 offen
    s_add_u32 s47, s27, 97280
    buffer_load_dwordx4 v[12:15], v5, s[16:19], s47 offen
    s_add_u32 s47, s28, 147456
    buffer_load_dwordx4 v[16:19], v5, s[16:19], s47 offen
    buffer_load_dwordx4 v[20:23], v5, s[16:19], s47 offen offset:1024
    s_waitcnt vmcnt(8)
    v_mfma_f32_32x32x16_bf16 v[64:79], v[32:35], v[24:27], v[64:79]
    v_mfma_f32_32x32x16_bf16 v[80:95], v[36:39], v[24:27], v[80:95]
    v_mfma_f32_32x32x16_bf16 v[96:111], v[32:35], v[28:31], v[96:111]
    v_mfma_f32_32x32x16_bf16 v[112:127], v[36:39], v[28:31], v[112:127]
    s_add_u32 s47, s27, 10240
    buffer_load_dwordx4 v[24:27], v5, s[16:19], s47 offen
    s_add_u32 s47, s27, 98304
    buffer_load_dwordx4 v[28:31], v5, s[16:19], s47 offen
    s_add_u32 s47, s28, 163840
    buffer_load_dwordx4 v[32:35], v5, s[16:19], s47 offen
    buffer_load_dwordx4 v[36:39], v5, s[16:19], s47 offen offset:1024
    s_waitcnt vmcnt(8)
    v_mfma_f32_32x32x16_bf16 v[64:79], v[48:51], v[40:43], v[64:79]
    v_mfma_f32_32x32x16_bf16 v[80:95], v[52:55], v[40:43], v[80:95]
    v_mfma_f32_32x32x16_bf16 v[96:111], v[48:51], v[44:47], v[96:111]
    v_mfma_f32_32x32x16_bf16 v[112:127], v[52:55], v[44:47], v[112:127]
    s_add_u32 s47, s27, 11264
    buffer_load_dwordx4 v[40:43], v5, s[16:19], s47 offen
    s_add_u32 s47, s27, 99328
    buffer_load_dwordx4 v[44:47], v5, s[16:19], s47 offen
    s_add_u32 s47, s28, 180224
    buffer_load_dwordx4 v[48:51], v5, s[16:19], s47 offen
    buffer_load_dwordx4 v[52:55], v5, s[16:19], s47 offen offset:1024
    s_waitcnt vmcnt(8)
    v_mfma_f32_32x32x16_bf16 v[64:79], v[16:19], v[8:11], v[64:79]
    v_mfma_f32_32x32x16_bf16 v[80:95], v[20:23], v[8:11], v[80:95]
    v_mfma_f32_32x32x16_bf16 v[96:111], v[16:19], v[12:15], v[96:111]
    v_mfma_f32_32x32x16_bf16 v[112:127], v[20:23], v[12:15], v[112:127]
    s_add_u32 s47, s27, 12288
    buffer_load_dwordx4 v[8:11], v5, s[16:19], s47 offen
    s_add_u32 s47, s27, 100352
    buffer_load_dwordx4 v[12:15], v5, s[16:19], s47 offen
    s_add_u32 s47, s28, 196608
    buffer_load_dwordx4 v[16:19], v5, s[16:19], s47 offen
    buffer_load_dwordx4 v[20:23], v5, s[16:19], s47 offen offset:1024
    s_waitcnt vmcnt(8)
    v_mfma_f32_32x32x16_bf16 v[64:79], v[32:35], v[24:27], v[64:79]
    v_mfma_f32_32x32x16_bf16 v[80:95], v[36:39], v[24:27], v[80:95]
    v_mfma_f32_32x32x16_bf16 v[96:111], v[32:35], v[28:31], v[96:111]
    v_mfma_f32_32x32x16_bf16 v[112:127], v[36:39], v[28:31], v[112:127]
    s_add_u32 s47, s27, 13312
    buffer_load_dwordx4 v[24:27], v5, s[16:19], s47 offen
    s_add_u32 s47, s27, 101376
    buffer_load_dwordx4 v[28:31], v5, s[16:19], s47 offen
    s_add_u32 s47, s28, 212992
    buffer_load_dwordx4 v[32:35], v5, s[16:19], s47 offen
    buffer_load_dwordx4 v[36:39], v5, s[16:19], s47 offen offset:1024
    s_waitcnt vmcnt(8)
    v_mfma_f32_32x32x16_bf16 v[64:79], v[48:51], v[40:43], v[64:79]
    v_mfma_f32_32x32x16_bf16 v[80:95], v[52:55], v[40:43], v[80:95]
    v_mfma_f32_32x32x16_bf16 v[96:111], v[48:51], v[44:47], v[96:111]
    v_mfma_f32_32x32x16_bf16 v[112:127], v[52:55], v[44:47], v[112:127]
    s_add_u32 s47, s27, 14336
    buffer_load_dwordx4 v[40:43], v5, s[16:19], s47 offen
    s_add_u32 s47, s27, 102400
    buffer_load_dwordx4 v[44:47], v5, s[16:19], s47 offen
    s_add_u32 s47, s28, 229376
    buffer_load_dwordx4 v[48:51], v5, s[16:19], s47 offen
    buffer_load_dwordx4 v[52:55], v5, s[16:19], s47 offen offset:1024
    s_waitcnt vmcnt(8)
    v_mfma_f32_32x32x16_bf16 v[64:79], v[16:19], v[8:11], v[64:79]
    v_mfma_f32_32x32x16_bf16 v[80:95], v[20:23], v[8:11], v[80:95]
    v_mfma_f32_32x32x16_bf16 v[96:111], v[16:19], v[12:15], v[96:111]
    v_mfma_f32_32x32x16_bf16 v[112:127], v[20:23], v[12:15], v[112:127]
    s_add_u32 s47, s27, 15360
    buffer_load_dwordx4 v[8:11], v5, s[16:19], s47 offen
    s_add_u32 s47, s27, 103424
    buffer_load_dwordx4 v[12:15], v5, s[16:19], s47 offen
    s_add_u32 s47, s28, 245760
    buffer_load_dwordx4 v[16:19], v5, s[16:19], s47 offen
    buffer_load_dwordx4 v[20:23], v5, s[16:19], s47 offen offset:1024
    s_waitcnt vmcnt(8)
    v_mfma_f32_32x32x16_bf16 v[64:79], v[32:35], v[24:27], v[64:79]
    v_mfma_f32_32x32x16_bf16 v[80:95], v[36:39], v[24:27], v[80:95]
    v_mfma_f32_32x32x16_bf16 v[96:111], v[32:35], v[28:31], v[96:111]
    v_mfma_f32_32x32x16_bf16 v[112:127], v[36:39], v[28:31], v[112:127]
    s_add_u32 s47, s27, 16384
    buffer_load_dwordx4 v[24:27], v5, s[16:19], s47 offen
    s_add_u32 s47, s27, 104448
    buffer_load_dwordx4 v[28:31], v5, s[16:19], s47 offen
    s_add_u32 s47, s28, 262144
    buffer_load_dwordx4 v[32:35], v5, s[16:19], s47 offen
    buffer_load_dwordx4 v[36:39], v5, s[16:19], s47 offen offset:1024
    s_waitcnt vmcnt(8)
    v_mfma_f32_32x32x16_bf16 v[64:79], v[48:51], v[40:43], v[64:79]
    v_mfma_f32_32x32x16_bf16 v[80:95], v[52:55], v[40:43], v[80:95]
    v_mfma_f32_32x32x16_bf16 v[96:111], v[48:51], v[44:47], v[96:111]
    v_mfma_f32_32x32x16_bf16 v[112:127], v[52:55], v[44:47], v[112:127]
    s_add_u32 s47, s27, 17408
    buffer_load_dwordx4 v[40:43], v5, s[16:19], s47 offen
    s_add_u32 s47, s27, 105472
    buffer_load_dwordx4 v[44:47], v5, s[16:19], s47 offen
    s_add_u32 s47, s28, 278528
    buffer_load_dwordx4 v[48:51], v5, s[16:19], s47 offen
    buffer_load_dwordx4 v[52:55], v5, s[16:19], s47 offen offset:1024
    s_waitcnt vmcnt(8)
    v_mfma_f32_32x32x16_bf16 v[64:79], v[16:19], v[8:11], v[64:79]
    v_mfma_f32_32x32x16_bf16 v[80:95], v[20:23], v[8:11], v[80:95]
    v_mfma_f32_32x32x16_bf16 v[96:111], v[16:19], v[12:15], v[96:111]
    v_mfma_f32_32x32x16_bf16 v[112:127], v[20:23], v[12:15], v[112:127]
    s_add_u32 s47, s27, 18432
    buffer_load_dwordx4 v[8:11], v5, s[16:19], s47 offen
    s_add_u32 s47, s27, 106496
    buffer_load_dwordx4 v[12:15], v5, s[16:19], s47 offen
    s_add_u32 s47, s28, 294912
    buffer_load_dwordx4 v[16:19], v5, s[16:19], s47 offen
    buffer_load_dwordx4 v[20:23], v5, s[16:19], s47 offen offset:1024
    s_waitcnt vmcnt(8)
    v_mfma_f32_32x32x16_bf16 v[64:79], v[32:35], v[24:27], v[64:79]
    v_mfma_f32_32x32x16_bf16 v[80:95], v[36:39], v[24:27], v[80:95]
    v_mfma_f32_32x32x16_bf16 v[96:111], v[32:35], v[28:31], v[96:111]
    v_mfma_f32_32x32x16_bf16 v[112:127], v[36:39], v[28:31], v[112:127]
    s_add_u32 s47, s27, 19456
    buffer_load_dwordx4 v[24:27], v5, s[16:19], s47 offen
    s_add_u32 s47, s27, 107520
    buffer_load_dwordx4 v[28:31], v5, s[16:19], s47 offen
    s_add_u32 s47, s28, 311296
    buffer_load_dwordx4 v[32:35], v5, s[16:19], s47 offen
    buffer_load_dwordx4 v[36:39], v5, s[16:19], s47 offen offset:1024
    s_waitcnt vmcnt(8)
    v_mfma_f32_32x32x16_bf16 v[64:79], v[48:51], v[40:43], v[64:79]
    v_mfma_f32_32x32x16_bf16 v[80:95], v[52:55], v[40:43], v[80:95]
    v_mfma_f32_32x32x16_bf16 v[96:111], v[48:51], v[44:47], v[96:111]
    v_mfma_f32_32x32x16_bf16 v[112:127], v[52:55], v[44:47], v[112:127]
    s_add_u32 s47, s27, 20480
    buffer_load_dwordx4 v[40:43], v5, s[16:19], s47 offen
    s_add_u32 s47, s27, 108544
    buffer_load_dwordx4 v[44:47], v5, s[16:19], s47 offen
    s_add_u32 s47, s28, 327680
    buffer_load_dwordx4 v[48:51], v5, s[16:19], s47 offen
    buffer_load_dwordx4 v[52:55], v5, s[16:19], s47 offen offset:1024
    s_waitcnt vmcnt(8)
    v_mfma_f32_32x32x16_bf16 v[64:79], v[16:19], v[8:11], v[64:79]
    v_mfma_f32_32x32x16_bf16 v[80:95], v[20:23], v[8:11], v[80:95]
    v_mfma_f32_32x32x16_bf16 v[96:111], v[16:19], v[12:15], v[96:111]
    v_mfma_f32_32x32x16_bf16 v[112:127], v[20:23], v[12:15], v[112:127]
    s_waitcnt vmcnt(4)
    v_mfma_f32_32x32x16_bf16 v[64:79], v[32:35], v[24:27], v[64:79]
    v_mfma_f32_32x32x16_bf16 v[80:95], v[36:39], v[24:27], v[80:95]
    v_mfma_f32_32x32x16_bf16 v[96:111], v[32:35], v[28:31], v[96:111]
    v_mfma_f32_32x32x16_bf16 v[112:127], v[36:39], v[28:31], v[112:127]
    s_waitcnt vmcnt(0)
    v_mfma_f32_32x32x16_bf16 v[64:79], v[48:51], v[40:43], v[64:79]
    v_mfma_f32_32x32x16_bf16 v[80:95], v[52:55], v[40:43], v[80:95]
    v_mfma_f32_32x32x16_bf16 v[96:111], v[48:51], v[44:47], v[96:111]
    v_mfma_f32_32x32x16_bf16 v[112:127], v[52:55], v[44:47], v[112:127]
    s_cmp_ge_u32 s23, 2
    s_cbranch_scc1 K2_NOX
    s_mul_i32 s48, s23, 20
    s_sub_u32 s48, 84, s48
    s_lshl_b32 s49, s48, 10
    s_add_u32 s27, s27, s49
    s_lshl_b32 s49, s48, 14
    s_add_u32 s28, s28, s49
    s_add_u32 s47, s27, 0
    buffer_load_dwordx4 v[8:11], v5, s[16:19], s47 offen
    s_add_u32 s47, s27, 88064
    buffer_load_dwordx4 v[12:15], v5, s[16:19], s47 offen
    s_add_u32 s47, s28, 0
    buffer_load_dwordx4 v[16:19], v5, s[16:19], s47 offen
    buffer_load_dwordx4 v[20:23], v5, s[16:19], s47 offen offset:1024
    s_waitcnt vmcnt(0)
    v_mfma_f32_32x32x16_bf16 v[64:79], v[16:19], v[8:11], v[64:79]
    v_mfma_f32_32x32x16_bf16 v[80:95], v[20:23], v[8:11], v[80:95]
    v_mfma_f32_32x32x16_bf16 v[96:111], v[16:19], v[12:15], v[96:111]
    v_mfma_f32_32x32x16_bf16 v[112:127], v[20:23], v[12:15], v[112:127]
K2_NOX:
    s_nop 15
    v_add_u32 v8, 131328, v5
    s_cmp_eq_u32 s23, 3
    s_cbranch_scc1 K2_RW
    s_sub_u32 s48, 3, s23
K2_RSPIN:
    ds_read_b32 v2, v6 offset:32
    s_waitcnt lgkmcnt(0)
    v_readfirstlane_b32 s47, v2
    s_nop 3
    s_cmp_ge_u32 s47, s48
    s_cbranch_scc1 K2_RGO
    s_sleep 4
    s_branch K2_RSPIN
K2_RGO:
    ds_read_b128 v[12:15], v8 offset:0
    ds_read_b128 v[16:19], v8 offset:1024
    ds_read_b128 v[20:23], v8 offset:2048
    ds_read_b128 v[24:27], v8 offset:3072
    ds_read_b128 v[28:31], v8 offset:4096
    ds_read_b128 v[32:35], v8 offset:5120
    ds_read_b128 v[36:39], v8 offset:6144
    ds_read_b128 v[40:43], v8 offset:7168
    s_waitcnt lgkmcnt(0)
    v_add_f32 v64, v64, v12
    v_add_f32 v65, v65, v13
    v_add_f32 v66, v66, v14
    v_add_f32 v67, v67, v15
    v_add_f32 v68, v68, v16
    v_add_f32 v69, v69, v17
    v_add_f32 v70, v70, v18
    v_add_f32 v71, v71, v19
    v_add_f32 v72, v72, v20
    v_add_f32 v73, v73, v21
    v_add_f32 v74, v74, v22
    v_add_f32 v75, v75, v23
    v_add_f32 v76, v76, v24
    v_add_f32 v77, v77, v25
    v_add_f32 v78, v78, v26
    v_add_f32 v79, v79, v27
    v_add_f32 v80, v80, v28
    v_add_f32 v81, v81, v29
    v_add_f32 v82, v82, v30
    v_add_f32 v83, v83, v31
    v_add_f32 v84, v84, v32
    v_add_f32 v85, v85, v33
    v_add_f32 v86, v86, v34
    v_add_f32 v87, v87, v35
    v_add_f32 v88, v88, v36
    v_add_f32 v89, v89, v37
    v_add_f32 v90, v90, v38
    v_add_f32 v91, v91, v39
    v_add_f32 v92, v92, v40
    v_add_f32 v93, v93, v41
    v_add_f32 v94, v94, v42
    v_add_f32 v95, v95, v43
    ds_read_b128 v[12:15], v8 offset:8192
    ds_read_b128 v[16:19], v8 offset:9216
    ds_read_b128 v[20:23], v8 offset:10240
    ds_read_b128 v[24:27], v8 offset:11264
    ds_read_b128 v[28:31], v8 offset:12288
    ds_read_b128 v[32:35], v8 offset:13312
    ds_read_b128 v[36:39], v8 offset:14336
    ds_read_b128 v[40:43], v8 offset:15360
    s_waitcnt lgkmcnt(0)
    v_add_f32 v96, v96, v12
    v_add_f32 v97, v97, v13
    v_add_f32 v98, v98, v14
    v_add_f32 v99, v99, v15
    v_add_f32 v100, v100, v16
    v_add_f32 v101, v101, v17
    v_add_f32 v102, v102, v18
    v_add_f32 v103, v103, v19
    v_add_f32 v104, v104, v20
    v_add_f32 v105, v105, v21
    v_add_f32 v106, v106, v22
    v_add_f32 v107, v107, v23
    v_add_f32 v108, v108, v24
    v_add_f32 v109, v109, v25
    v_add_f32 v110, v110, v26
    v_add_f32 v111, v111, v27
    v_add_f32 v112, v112, v28
    v_add_f32 v113, v113, v29
    v_add_f32 v114, v114, v30
    v_add_f32 v115, v115, v31
    v_add_f32 v116, v116, v32
    v_add_f32 v117, v117, v33
    v_add_f32 v118, v118, v34
    v_add_f32 v119, v119, v35
    v_add_f32 v120, v120, v36
    v_add_f32 v121, v121, v37
    v_add_f32 v122, v122, v38
    v_add_f32 v123, v123, v39
    v_add_f32 v124, v124, v40
    v_add_f32 v125, v125, v41
    v_add_f32 v126, v126, v42
    v_add_f32 v127, v127, v43
    s_cmp_eq_u32 s23, 0
    s_cbranch_scc1 K2_RST
K2_RW:
    ds_write_b128 v8, v[64:67] offset:0
    ds_write_b128 v8, v[68:71] offset:1024
    ds_write_b128 v8, v[72:75] offset:2048
    ds_write_b128 v8, v[76:79] offset:3072
    ds_write_b128 v8, v[80:83] offset:4096
    ds_write_b128 v8, v[84:87] offset:5120
    ds_write_b128 v8, v[88:91] offset:6144
    ds_write_b128 v8, v[92:95] offset:7168
    ds_write_b128 v8, v[96:99] offset:8192
    ds_write_b128 v8, v[100:103] offset:9216
    ds_write_b128 v8, v[104:107] offset:10240
    ds_write_b128 v8, v[108:111] offset:11264
    ds_write_b128 v8, v[112:115] offset:12288
    ds_write_b128 v8, v[116:119] offset:13312
    ds_write_b128 v8, v[120:123] offset:14336
    ds_write_b128 v8, v[124:127] offset:15360
    s_waitcnt lgkmcnt(0)
    s_mov_b64 exec, 1
    ds_add_u32 v6, v7 offset:32
    s_waitcnt lgkmcnt(0)
    s_mov_b64 exec, -1
    s_endpgm
K2_RST:
    s_lshl_b32 s47, s20, 1
    s_add_u32 s47, s47, 0
    s_lshl_b32 s47, s47, 4
    s_lshl_b32 s48, s21, 1
    s_add_u32 s47, s47, s48
    s_add_u32 s47, s47, 0
    s_lshl_b32 s47, s47, 11
    s_add_u32 s47, s47, 16777216
    v_cvt_pk_bf16_f32 v64, v64, v65
    v_cvt_pk_bf16_f32 v65, v66, v67
    v_cvt_pk_bf16_f32 v66, v68, v69
    v_cvt_pk_bf16_f32 v67, v70, v71
    v_cvt_pk_bf16_f32 v68, v72, v73
    v_cvt_pk_bf16_f32 v69, v74, v75
    v_cvt_pk_bf16_f32 v70, v76, v77
    v_cvt_pk_bf16_f32 v71, v78, v79
    buffer_store_dwordx4 v[64:67], v5, s[16:19], s47 offen offset:0 sc1
    buffer_store_dwordx4 v[68:71], v5, s[16:19], s47 offen offset:1024 sc1
    s_lshl_b32 s47, s20, 1
    s_add_u32 s47, s47, 0
    s_lshl_b32 s47, s47, 4
    s_lshl_b32 s48, s21, 1
    s_add_u32 s47, s47, s48
    s_add_u32 s47, s47, 1
    s_lshl_b32 s47, s47, 11
    s_add_u32 s47, s47, 16777216
    v_cvt_pk_bf16_f32 v80, v80, v81
    v_cvt_pk_bf16_f32 v81, v82, v83
    v_cvt_pk_bf16_f32 v82, v84, v85
    v_cvt_pk_bf16_f32 v83, v86, v87
    v_cvt_pk_bf16_f32 v84, v88, v89
    v_cvt_pk_bf16_f32 v85, v90, v91
    v_cvt_pk_bf16_f32 v86, v92, v93
    v_cvt_pk_bf16_f32 v87, v94, v95
    buffer_store_dwordx4 v[80:83], v5, s[16:19], s47 offen offset:0 sc1
    buffer_store_dwordx4 v[84:87], v5, s[16:19], s47 offen offset:1024 sc1
    s_lshl_b32 s47, s20, 1
    s_add_u32 s47, s47, 1
    s_lshl_b32 s47, s47, 4
    s_lshl_b32 s48, s21, 1
    s_add_u32 s47, s47, s48
    s_add_u32 s47, s47, 0
    s_lshl_b32 s47, s47, 11
    s_add_u32 s47, s47, 16777216
    v_cvt_pk_bf16_f32 v96, v96, v97
    v_cvt_pk_bf16_f32 v97, v98, v99
    v_cvt_pk_bf16_f32 v98, v100, v101
    v_cvt_pk_bf16_f32 v99, v102, v103
    v_cvt_pk_bf16_f32 v100, v104, v105
    v_cvt_pk_bf16_f32 v101, v106, v107
    v_cvt_pk_bf16_f32 v102, v108, v109
    v_cvt_pk_bf16_f32 v103, v110, v111
    buffer_store_dwordx4 v[96:99], v5, s[16:19], s47 offen offset:0 sc1
    buffer_store_dwordx4 v[100:103], v5, s[16:19], s47 offen offset:1024 sc1
    s_lshl_b32 s47, s20, 1
    s_add_u32 s47, s47, 1
    s_lshl_b32 s47, s47, 4
    s_lshl_b32 s48, s21, 1
    s_add_u32 s47, s47, s48
    s_add_u32 s47, s47, 1
    s_lshl_b32 s47, s47, 11
    s_add_u32 s47, s47, 16777216
    v_cvt_pk_bf16_f32 v112, v112, v113
    v_cvt_pk_bf16_f32 v113, v114, v115
    v_cvt_pk_bf16_f32 v114, v116, v117
    v_cvt_pk_bf16_f32 v115, v118, v119
    v_cvt_pk_bf16_f32 v116, v120, v121
    v_cvt_pk_bf16_f32 v117, v122, v123
    v_cvt_pk_bf16_f32 v118, v124, v125
    v_cvt_pk_bf16_f32 v119, v126, v127
    buffer_store_dwordx4 v[112:115], v5, s[16:19], s47 offen offset:0 sc1
    buffer_store_dwordx4 v[116:119], v5, s[16:19], s47 offen offset:1024 sc1
K2_END:
    s_endpgm
K2_ATT:
    s_lshl_b32 s47, s21, 3
    s_add_u32 s47, s47, s22
    s_lshl_b32 s47, s47, 10
    s_add_u32 s47, s47, s44
    s_add_u32 s47, s47, 0
    buffer_load_dwordx4 v[8:11], v5, s[16:19], s47 offen
    v_mov_b32 v13, 131072
    v_mov_b32 v3, 0
    v_and_b32 v2, 31, v1
    v_mov_b32 v4, 0x3f803f80
    v_and_b32 v14, 27, v2
    v_cmp_eq_u32 vcc, 16, v14
    s_nop 1
    v_cndmask_b32 v3, v3, v4, vcc
    v_mov_b32 v100, v3
    v_mov_b32 v101, v3
    v_mov_b32 v102, v3
    v_mov_b32 v103, v3
    v_mov_b32 v104, v3
    v_mov_b32 v105, v3
    v_mov_b32 v106, v3
    v_mov_b32 v107, v3
    v_mov_b32 v108, v3
    v_mov_b32 v109, v3
    v_mov_b32 v110, v3
    v_mov_b32 v111, v3
    v_mov_b32 v112, v3
    v_mov_b32 v113, v3
    v_mov_b32 v114, v3
    v_mov_b32 v115, v3
    v_cmp_gt_u32 vcc, 16, v2
    s_nop 1
    s_mov_b64 s[24:25], vcc
    v_mov_b32 v6, v5
    v_lshrrev_b32 v3, 5, v1
    v_lshlrev_b32 v3, 8, v3
    v_and_b32 v4, 15, v1
    v_lshl_add_u32 v7, v4, 4, v3
    v_add_u32 v7, 65536, v7
    s_barrier
K2_WC1:
    ds_read_b32 v2, v13 offset:0
    s_waitcnt lgkmcnt(0)
    v_readfirstlane_b32 s47, v2
    s_nop 3
    s_cmp_ge_u32 s47, 4
    s_cbranch_scc1 K2_WC1D
    s_sleep 2
    s_branch K2_WC1
K2_WC1D:
    s_waitcnt vmcnt(0)
    ds_read_b128 v[88:91], v6
    s_waitcnt lgkmcnt(0)
    v_mfma_f32_32x32x16_bf16 v[32:47], v[88:91], v[8:11], 0
    s_nop 15
    v_max3_f32 v12, v32, v33, v34
    v_max3_f32 v12, v12, v35, v36
    v_max3_f32 v12, v12, v37, v38
    v_max3_f32 v12, v12, v39, v40
    v_max3_f32 v12, v12, v41, v42
    v_max3_f32 v12, v12, v43, v44
    v_max3_f32 v12, v12, v45, v46
    v_max_f32 v12, v12, v47
    v_mov_b32 v3, v12
    s_nop 1
    v_permlane32_swap_b32 v12, v3
    v_max_f32 v12, v12, v3
    v_sub_f32 v12, 0, v12
    v_mov_b32 v16, v12
    v_mov_b32 v17, v12
    v_mov_b32 v18, v12
    v_mov_b32 v19, v12
    v_mov_b32 v20, v12
    v_mov_b32 v21, v12
    v_mov_b32 v22, v12
    v_mov_b32 v23, v12
    v_mov_b32 v24, v12
    v_mov_b32 v25, v12
    v_mov_b32 v26, v12
    v_mov_b32 v27, v12
    v_mov_b32 v28, v12
    v_mov_b32 v29, v12
    v_mov_b32 v30, v12
    v_mov_b32 v31, v12
    s_mov_b32 s26, 0
K2_PASS2:
    ds_read_b128 v[88:91], v6 offset:0
    ds_read_b128 v[92:95], v6 offset:1024
    s_mov_b64 exec, s[24:25]
    ds_read_b128 v[100:103], v7 offset:0
    ds_read_b128 v[104:107], v7 offset:512
    s_mov_b64 exec, -1
    s_waitcnt lgkmcnt(0)
    v_mfma_f32_32x32x16_bf16 v[32:47], v[88:91], v[8:11], v[16:31]
    s_nop 7
    ds_read_b128 v[96:99], v6 offset:2048
    s_mov_b64 exec, s[24:25]
    ds_read_b128 v[108:111], v7 offset:1024
    ds_read_b128 v[112:115], v7 offset:1536
    s_mov_b64 exec, -1
    s_waitcnt lgkmcnt(3)
    v_mfma_f32_32x32x16_bf16 v[48:63], v[92:95], v[8:11], v[16:31]
    v_exp_f32 v32, v32
    v_exp_f32 v33, v33
    v_exp_f32 v34, v34
    v_exp_f32 v35, v35
    v_exp_f32 v36, v36
    v_exp_f32 v37, v37
    v_exp_f32 v38, v38
    v_exp_f32 v39, v39
    v_cvt_pk_bf16_f32 v80, v32, v33
    v_cvt_pk_bf16_f32 v81, v34, v35
    v_cvt_pk_bf16_f32 v82, v36, v37
    v_cvt_pk_bf16_f32 v83, v38, v39
    s_nop 1
    v_mfma_f32_32x32x16_bf16 v[64:79], v[100:103], v[80:83], 0
    v_exp_f32 v40, v40
    v_exp_f32 v41, v41
    v_exp_f32 v42, v42
    v_exp_f32 v43, v43
    v_exp_f32 v44, v44
    v_exp_f32 v45, v45
    v_exp_f32 v46, v46
    v_exp_f32 v47, v47
    v_cvt_pk_bf16_f32 v84, v40, v41
    v_cvt_pk_bf16_f32 v85, v42, v43
    v_cvt_pk_bf16_f32 v86, v44, v45
    v_cvt_pk_bf16_f32 v87, v46, v47
    s_nop 1
    v_mfma_f32_32x32x16_bf16 v[64:79], v[104:107], v[84:87], v[64:79]
    ds_read_b128 v[88:91], v6 offset:3072
    s_mov_b64 exec, s[24:25]
    ds_read_b128 v[100:103], v7 offset:2048
    ds_read_b128 v[104:107], v7 offset:2560
    s_mov_b64 exec, -1
    s_waitcnt lgkmcnt(3)
    v_mfma_f32_32x32x16_bf16 v[32:47], v[96:99], v[8:11], v[16:31]
    v_exp_f32 v48, v48
    v_exp_f32 v49, v49
    v_exp_f32 v50, v50
    v_exp_f32 v51, v51
    v_exp_f32 v52, v52
    v_exp_f32 v53, v53
    v_exp_f32 v54, v54
    v_exp_f32 v55, v55
    v_cvt_pk_bf16_f32 v80, v48, v49
    v_cvt_pk_bf16_f32 v81, v50, v51
    v_cvt_pk_bf16_f32 v82, v52, v53
    v_cvt_pk_bf16_f32 v83, v54, v55
    s_nop 1
    v_mfma_f32_32x32x16_bf16 v[64:79], v[108:111], v[80:83], v[64:79]
    v_exp_f32 v56, v56
    v_exp_f32 v57, v57
    v_exp_f32 v58, v58
    v_exp_f32 v59, v59
    v_exp_f32 v60, v60
    v_exp_f32 v61, v61
    v_exp_f32 v62, v62
    v_exp_f32 v63, v63
    v_cvt_pk_bf16_f32 v84, v56, v57
    v_cvt_pk_bf16_f32 v85, v58, v59
    v_cvt_pk_bf16_f32 v86, v60, v61
    v_cvt_pk_bf16_f32 v87, v62, v63
    s_nop 1
    v_mfma_f32_32x32x16_bf16 v[64:79], v[112:115], v[84:87], v[64:79]
K2_WC2:
    ds_read_b32 v2, v13 offset:4
    s_waitcnt lgkmcnt(0)
    v_readfirstlane_b32 s47, v2
    s_nop 3
    s_cmp_ge_u32 s47, 4
    s_cbranch_scc1 K2_WC2D
    s_sleep 2
    s_branch K2_WC2
K2_WC2D:
    ds_read_b128 v[92:95], v6 offset:4096
    s_mov_b64 exec, s[24:25]
    ds_read_b128 v[108:111], v7 offset:3072
    ds_read_b128 v[112:115], v7 offset:3584
    s_mov_b64 exec, -1
    s_waitcnt lgkmcnt(3)
    v_mfma_f32_32x32x16_bf16 v[48:63], v[88:91], v[8:11], v[16:31]
    v_exp_f32 v32, v32
    v_exp_f32 v33, v33
    v_exp_f32 v34, v34
    v_exp_f32 v35, v35
    v_exp_f32 v36, v36
    v_exp_f32 v37, v37
    v_exp_f32 v38, v38
    v_exp_f32 v39, v39
    v_cvt_pk_bf16_f32 v80, v32, v33
    v_cvt_pk_bf16_f32 v81, v34, v35
    v_cvt_pk_bf16_f32 v82, v36, v37
    v_cvt_pk_bf16_f32 v83, v38, v39
    s_nop 1
    v_mfma_f32_32x32x16_bf16 v[64:79], v[100:103], v[80:83], v[64:79]
    v_exp_f32 v40, v40
    v_exp_f32 v41, v41
    v_exp_f32 v42, v42
    v_exp_f32 v43, v43
    v_exp_f32 v44, v44
    v_exp_f32 v45, v45
    v_exp_f32 v46, v46
    v_exp_f32 v47, v47
    v_cvt_pk_bf16_f32 v84, v40, v41
    v_cvt_pk_bf16_f32 v85, v42, v43
    v_cvt_pk_bf16_f32 v86, v44, v45
    v_cvt_pk_bf16_f32 v87, v46, v47
    s_nop 1
    v_mfma_f32_32x32x16_bf16 v[64:79], v[104:107], v[84:87], v[64:79]
    ds_read_b128 v[96:99], v6 offset:5120
    s_mov_b64 exec, s[24:25]
    ds_read_b128 v[100:103], v7 offset:4096
    ds_read_b128 v[104:107], v7 offset:4608
    s_mov_b64 exec, -1
    s_waitcnt lgkmcnt(3)
    v_mfma_f32_32x32x16_bf16 v[32:47], v[92:95], v[8:11], v[16:31]
    v_exp_f32 v48, v48
    v_exp_f32 v49, v49
    v_exp_f32 v50, v50
    v_exp_f32 v51, v51
    v_exp_f32 v52, v52
    v_exp_f32 v53, v53
    v_exp_f32 v54, v54
    v_exp_f32 v55, v55
    v_cvt_pk_bf16_f32 v80, v48, v49
    v_cvt_pk_bf16_f32 v81, v50, v51
    v_cvt_pk_bf16_f32 v82, v52, v53
    v_cvt_pk_bf16_f32 v83, v54, v55
    s_nop 1
    v_mfma_f32_32x32x16_bf16 v[64:79], v[108:111], v[80:83], v[64:79]
    v_exp_f32 v56, v56
    v_exp_f32 v57, v57
    v_exp_f32 v58, v58
    v_exp_f32 v59, v59
    v_exp_f32 v60, v60
    v_exp_f32 v61, v61
    v_exp_f32 v62, v62
    v_exp_f32 v63, v63
    v_cvt_pk_bf16_f32 v84, v56, v57
    v_cvt_pk_bf16_f32 v85, v58, v59
    v_cvt_pk_bf16_f32 v86, v60, v61
    v_cvt_pk_bf16_f32 v87, v62, v63
    s_nop 1
    v_mfma_f32_32x32x16_bf16 v[64:79], v[112:115], v[84:87], v[64:79]
    ds_read_b128 v[88:91], v6 offset:6144
    s_mov_b64 exec, s[24:25]
    ds_read_b128 v[108:111], v7 offset:5120
    ds_read_b128 v[112:115], v7 offset:5632
    s_mov_b64 exec, -1
    s_waitcnt lgkmcnt(3)
    v_mfma_f32_32x32x16_bf16 v[48:63], v[96:99], v[8:11], v[16:31]
    v_exp_f32 v32, v32
    v_exp_f32 v33, v33
    v_exp_f32 v34, v34
    v_exp_f32 v35, v35
    v_exp_f32 v36, v36
    v_exp_f32 v37, v37
    v_exp_f32 v38, v38
    v_exp_f32 v39, v39
    v_cvt_pk_bf16_f32 v80, v32, v33
    v_cvt_pk_bf16_f32 v81, v34, v35
    v_cvt_pk_bf16_f32 v82, v36, v37
    v_cvt_pk_bf16_f32 v83, v38, v39
    s_nop 1
    v_mfma_f32_32x32x16_bf16 v[64:79], v[100:103], v[80:83], v[64:79]
    v_exp_f32 v40, v40
    v_exp_f32 v41, v41
    v_exp_f32 v42, v42
    v_exp_f32 v43, v43
    v_exp_f32 v44, v44
    v_exp_f32 v45, v45
    v_exp_f32 v46, v46
    v_exp_f32 v47, v47
    v_cvt_pk_bf16_f32 v84, v40, v41
    v_cvt_pk_bf16_f32 v85, v42, v43
    v_cvt_pk_bf16_f32 v86, v44, v45
    v_cvt_pk_bf16_f32 v87, v46, v47
    s_nop 1
    v_mfma_f32_32x32x16_bf16 v[64:79], v[104:107], v[84:87], v[64:79]
    ds_read_b128 v[92:95], v6 offset:7168
    s_mov_b64 exec, s[24:25]
    ds_read_b128 v[100:103], v7 offset:6144
    ds_read_b128 v[104:107], v7 offset:6656
    s_mov_b64 exec, -1
    s_waitcnt lgkmcnt(3)
    v_mfma_f32_32x32x16_bf16 v[32:47], v[88:91], v[8:11], v[16:31]
    v_exp_f32 v48, v48
    v_exp_f32 v49, v49
    v_exp_f32 v50, v50
    v_exp_f32 v51, v51
    v_exp_f32 v52, v52
    v_exp_f32 v53, v53
    v_exp_f32 v54, v54
    v_exp_f32 v55, v55
    v_cvt_pk_bf16_f32 v80, v48, v49
    v_cvt_pk_bf16_f32 v81, v50, v51
    v_cvt_pk_bf16_f32 v82, v52, v53
    v_cvt_pk_bf16_f32 v83, v54, v55
    s_nop 1
    v_mfma_f32_32x32x16_bf16 v[64:79], v[108:111], v[80:83], v[64:79]
    v_exp_f32 v56, v56
    v_exp_f32 v57, v57
    v_exp_f32 v58, v58
    v_exp_f32 v59, v59
    v_exp_f32 v60, v60
    v_exp_f32 v61, v61
    v_exp_f32 v62, v62
    v_exp_f32 v63, v63
    v_cvt_pk_bf16_f32 v84, v56, v57
    v_cvt_pk_bf16_f32 v85, v58, v59
    v_cvt_pk_bf16_f32 v86, v60, v61
    v_cvt_pk_bf16_f32 v87, v62, v63
    s_nop 1
    v_mfma_f32_32x32x16_bf16 v[64:79], v[112:115], v[84:87], v[64:79]
    ds_read_b128 v[96:99], v6 offset:8192
    s_mov_b64 exec, s[24:25]
    ds_read_b128 v[108:111], v7 offset:7168
    ds_read_b128 v[112:115], v7 offset:7680
    s_mov_b64 exec, -1
    s_waitcnt lgkmcnt(3)
    v_mfma_f32_32x32x16_bf16 v[48:63], v[92:95], v[8:11], v[16:31]
    v_exp_f32 v32, v32
    v_exp_f32 v33, v33
    v_exp_f32 v34, v34
    v_exp_f32 v35, v35
    v_exp_f32 v36, v36
    v_exp_f32 v37, v37
    v_exp_f32 v38, v38
    v_exp_f32 v39, v39
    v_cvt_pk_bf16_f32 v80, v32, v33
    v_cvt_pk_bf16_f32 v81, v34, v35
    v_cvt_pk_bf16_f32 v82, v36, v37
    v_cvt_pk_bf16_f32 v83, v38, v39
    s_nop 1
    v_mfma_f32_32x32x16_bf16 v[64:79], v[100:103], v[80:83], v[64:79]
    v_exp_f32 v40, v40
    v_exp_f32 v41, v41
    v_exp_f32 v42, v42
    v_exp_f32 v43, v43
    v_exp_f32 v44, v44
    v_exp_f32 v45, v45
    v_exp_f32 v46, v46
    v_exp_f32 v47, v47
    v_cvt_pk_bf16_f32 v84, v40, v41
    v_cvt_pk_bf16_f32 v85, v42, v43
    v_cvt_pk_bf16_f32 v86, v44, v45
    v_cvt_pk_bf16_f32 v87, v46, v47
    s_nop 1
    v_mfma_f32_32x32x16_bf16 v[64:79], v[104:107], v[84:87], v[64:79]
    ds_read_b128 v[88:91], v6 offset:9216
    s_mov_b64 exec, s[24:25]
    ds_read_b128 v[100:103], v7 offset:8192
    ds_read_b128 v[104:107], v7 offset:8704
    s_mov_b64 exec, -1
    s_waitcnt lgkmcnt(3)
    v_mfma_f32_32x32x16_bf16 v[32:47], v[96:99], v[8:11], v[16:31]
    v_exp_f32 v48, v48
    v_exp_f32 v49, v49
    v_exp_f32 v50, v50
    v_exp_f32 v51, v51
    v_exp_f32 v52, v52
    v_exp_f32 v53, v53
    v_exp_f32 v54, v54
    v_exp_f32 v55, v55
    v_cvt_pk_bf16_f32 v80, v48, v49
    v_cvt_pk_bf16_f32 v81, v50, v51
    v_cvt_pk_bf16_f32 v82, v52, v53
    v_cvt_pk_bf16_f32 v83, v54, v55
    s_nop 1
    v_mfma_f32_32x32x16_bf16 v[64:79], v[108:111], v[80:83], v[64:79]
    v_exp_f32 v56, v56
    v_exp_f32 v57, v57
    v_exp_f32 v58, v58
    v_exp_f32 v59, v59
    v_exp_f32 v60, v60
    v_exp_f32 v61, v61
    v_exp_f32 v62, v62
    v_exp_f32 v63, v63
    v_cvt_pk_bf16_f32 v84, v56, v57
    v_cvt_pk_bf16_f32 v85, v58, v59
    v_cvt_pk_bf16_f32 v86, v60, v61
    v_cvt_pk_bf16_f32 v87, v62, v63
    s_nop 1
    v_mfma_f32_32x32x16_bf16 v[64:79], v[112:115], v[84:87], v[64:79]
    ds_read_b128 v[92:95], v6 offset:10240
    s_mov_b64 exec, s[24:25]
    ds_read_b128 v[108:111], v7 offset:9216
    ds_read_b128 v[112:115], v7 offset:9728
    s_mov_b64 exec, -1
    s_waitcnt lgkmcnt(3)
    v_mfma_f32_32x32x16_bf16 v[48:63], v[88:91], v[8:11], v[16:31]
    v_exp_f32 v32, v32
    v_exp_f32 v33, v33
    v_exp_f32 v34, v34
    v_exp_f32 v35, v35
    v_exp_f32 v36, v36
    v_exp_f32 v37, v37
    v_exp_f32 v38, v38
    v_exp_f32 v39, v39
    v_cvt_pk_bf16_f32 v80, v32, v33
    v_cvt_pk_bf16_f32 v81, v34, v35
    v_cvt_pk_bf16_f32 v82, v36, v37
    v_cvt_pk_bf16_f32 v83, v38, v39
    s_nop 1
    v_mfma_f32_32x32x16_bf16 v[64:79], v[100:103], v[80:83], v[64:79]
    v_exp_f32 v40, v40
    v_exp_f32 v41, v41
    v_exp_f32 v42, v42
    v_exp_f32 v43, v43
    v_exp_f32 v44, v44
    v_exp_f32 v45, v45
    v_exp_f32 v46, v46
    v_exp_f32 v47, v47
    v_cvt_pk_bf16_f32 v84, v40, v41
    v_cvt_pk_bf16_f32 v85, v42, v43
    v_cvt_pk_bf16_f32 v86, v44, v45
    v_cvt_pk_bf16_f32 v87, v46, v47
    s_nop 1
    v_mfma_f32_32x32x16_bf16 v[64:79], v[104:107], v[84:87], v[64:79]
    ds_read_b128 v[96:99], v6 offset:11264
    s_mov_b64 exec, s[24:25]
    ds_read_b128 v[100:103], v7 offset:10240
    ds_read_b128 v[104:107], v7 offset:10752
    s_mov_b64 exec, -1
    s_waitcnt lgkmcnt(3)
    v_mfma_f32_32x32x16_bf16 v[32:47], v[92:95], v[8:11], v[16:31]
    v_exp_f32 v48, v48
    v_exp_f32 v49, v49
    v_exp_f32 v50, v50
    v_exp_f32 v51, v51
    v_exp_f32 v52, v52
    v_exp_f32 v53, v53
    v_exp_f32 v54, v54
    v_exp_f32 v55, v55
    v_cvt_pk_bf16_f32 v80, v48, v49
    v_cvt_pk_bf16_f32 v81, v50, v51
    v_cvt_pk_bf16_f32 v82, v52, v53
    v_cvt_pk_bf16_f32 v83, v54, v55
    s_nop 1
    v_mfma_f32_32x32x16_bf16 v[64:79], v[108:111], v[80:83], v[64:79]
    v_exp_f32 v56, v56
    v_exp_f32 v57, v57
    v_exp_f32 v58, v58
    v_exp_f32 v59, v59
    v_exp_f32 v60, v60
    v_exp_f32 v61, v61
    v_exp_f32 v62, v62
    v_exp_f32 v63, v63
    v_cvt_pk_bf16_f32 v84, v56, v57
    v_cvt_pk_bf16_f32 v85, v58, v59
    v_cvt_pk_bf16_f32 v86, v60, v61
    v_cvt_pk_bf16_f32 v87, v62, v63
    s_nop 1
    v_mfma_f32_32x32x16_bf16 v[64:79], v[112:115], v[84:87], v[64:79]
    ds_read_b128 v[88:91], v6 offset:12288
    s_mov_b64 exec, s[24:25]
    ds_read_b128 v[108:111], v7 offset:11264
    ds_read_b128 v[112:115], v7 offset:11776
    s_mov_b64 exec, -1
    s_waitcnt lgkmcnt(3)
    v_mfma_f32_32x32x16_bf16 v[48:63], v[96:99], v[8:11], v[16:31]
    v_exp_f32 v32, v32
    v_exp_f32 v33, v33
    v_exp_f32 v34, v34
    v_exp_f32 v35, v35
    v_exp_f32 v36, v36
    v_exp_f32 v37, v37
    v_exp_f32 v38, v38
    v_exp_f32 v39, v39
    v_cvt_pk_bf16_f32 v80, v32, v33
    v_cvt_pk_bf16_f32 v81, v34, v35
    v_cvt_pk_bf16_f32 v82, v36, v37
    v_cvt_pk_bf16_f32 v83, v38, v39
    s_nop 1
    v_mfma_f32_32x32x16_bf16 v[64:79], v[100:103], v[80:83], v[64:79]
    v_exp_f32 v40, v40
    v_exp_f32 v41, v41
    v_exp_f32 v42, v42
    v_exp_f32 v43, v43
    v_exp_f32 v44, v44
    v_exp_f32 v45, v45
    v_exp_f32 v46, v46
    v_exp_f32 v47, v47
    v_cvt_pk_bf16_f32 v84, v40, v41
    v_cvt_pk_bf16_f32 v85, v42, v43
    v_cvt_pk_bf16_f32 v86, v44, v45
    v_cvt_pk_bf16_f32 v87, v46, v47
    s_nop 1
    v_mfma_f32_32x32x16_bf16 v[64:79], v[104:107], v[84:87], v[64:79]
    ds_read_b128 v[92:95], v6 offset:13312
    s_mov_b64 exec, s[24:25]
    ds_read_b128 v[100:103], v7 offset:12288
    ds_read_b128 v[104:107], v7 offset:12800
    s_mov_b64 exec, -1
    s_waitcnt lgkmcnt(3)
    v_mfma_f32_32x32x16_bf16 v[32:47], v[88:91], v[8:11], v[16:31]
    v_exp_f32 v48, v48
    v_exp_f32 v49, v49
    v_exp_f32 v50, v50
    v_exp_f32 v51, v51
    v_exp_f32 v52, v52
    v_exp_f32 v53, v53
    v_exp_f32 v54, v54
    v_exp_f32 v55, v55
    v_cvt_pk_bf16_f32 v80, v48, v49
    v_cvt_pk_bf16_f32 v81, v50, v51
    v_cvt_pk_bf16_f32 v82, v52, v53
    v_cvt_pk_bf16_f32 v83, v54, v55
    s_nop 1
    v_mfma_f32_32x32x16_bf16 v[64:79], v[108:111], v[80:83], v[64:79]
    v_exp_f32 v56, v56
    v_exp_f32 v57, v57
    v_exp_f32 v58, v58
    v_exp_f32 v59, v59
    v_exp_f32 v60, v60
    v_exp_f32 v61, v61
    v_exp_f32 v62, v62
    v_exp_f32 v63, v63
    v_cvt_pk_bf16_f32 v84, v56, v57
    v_cvt_pk_bf16_f32 v85, v58, v59
    v_cvt_pk_bf16_f32 v86, v60, v61
    v_cvt_pk_bf16_f32 v87, v62, v63
    s_nop 1
    v_mfma_f32_32x32x16_bf16 v[64:79], v[112:115], v[84:87], v[64:79]
    ds_read_b128 v[96:99], v6 offset:14336
    s_mov_b64 exec, s[24:25]
    ds_read_b128 v[108:111], v7 offset:13312
    ds_read_b128 v[112:115], v7 offset:13824
    s_mov_b64 exec, -1
    s_waitcnt lgkmcnt(3)
    v_mfma_f32_32x32x16_bf16 v[48:63], v[92:95], v[8:11], v[16:31]
    v_exp_f32 v32, v32
    v_exp_f32 v33, v33
    v_exp_f32 v34, v34
    v_exp_f32 v35, v35
    v_exp_f32 v36, v36
    v_exp_f32 v37, v37
    v_exp_f32 v38, v38
    v_exp_f32 v39, v39
    v_cvt_pk_bf16_f32 v80, v32, v33
    v_cvt_pk_bf16_f32 v81, v34, v35
    v_cvt_pk_bf16_f32 v82, v36, v37
    v_cvt_pk_bf16_f32 v83, v38, v39
    s_nop 1
    v_mfma_f32_32x32x16_bf16 v[64:79], v[100:103], v[80:83], v[64:79]
    v_exp_f32 v40, v40
    v_exp_f32 v41, v41
    v_exp_f32 v42, v42
    v_exp_f32 v43, v43
    v_exp_f32 v44, v44
    v_exp_f32 v45, v45
    v_exp_f32 v46, v46
    v_exp_f32 v47, v47
    v_cvt_pk_bf16_f32 v84, v40, v41
    v_cvt_pk_bf16_f32 v85, v42, v43
    v_cvt_pk_bf16_f32 v86, v44, v45
    v_cvt_pk_bf16_f32 v87, v46, v47
    s_nop 1
    v_mfma_f32_32x32x16_bf16 v[64:79], v[104:107], v[84:87], v[64:79]
    ds_read_b128 v[88:91], v6 offset:15360
    s_mov_b64 exec, s[24:25]
    ds_read_b128 v[100:103], v7 offset:14336
    ds_read_b128 v[104:107], v7 offset:14848
    s_mov_b64 exec, -1
    s_waitcnt lgkmcnt(3)
    v_mfma_f32_32x32x16_bf16 v[32:47], v[96:99], v[8:11], v[16:31]
    v_exp_f32 v48, v48
    v_exp_f32 v49, v49
    v_exp_f32 v50, v50
    v_exp_f32 v51, v51
    v_exp_f32 v52, v52
    v_exp_f32 v53, v53
    v_exp_f32 v54, v54
    v_exp_f32 v55, v55
    v_cvt_pk_bf16_f32 v80, v48, v49
    v_cvt_pk_bf16_f32 v81, v50, v51
    v_cvt_pk_bf16_f32 v82, v52, v53
    v_cvt_pk_bf16_f32 v83, v54, v55
    s_nop 1
    v_mfma_f32_32x32x16_bf16 v[64:79], v[108:111], v[80:83], v[64:79]
    v_exp_f32 v56, v56
    v_exp_f32 v57, v57
    v_exp_f32 v58, v58
    v_exp_f32 v59, v59
    v_exp_f32 v60, v60
    v_exp_f32 v61, v61
    v_exp_f32 v62, v62
    v_exp_f32 v63, v63
    v_cvt_pk_bf16_f32 v84, v56, v57
    v_cvt_pk_bf16_f32 v85, v58, v59
    v_cvt_pk_bf16_f32 v86, v60, v61
    v_cvt_pk_bf16_f32 v87, v62, v63
    s_nop 1
    v_mfma_f32_32x32x16_bf16 v[64:79], v[112:115], v[84:87], v[64:79]
K2_WC3:
    ds_read_b32 v2, v13 offset:8
    s_waitcnt lgkmcnt(0)
    v_readfirstlane_b32 s47, v2
    s_nop 3
    s_cmp_ge_u32 s47, 4
    s_cbranch_scc1 K2_WC3D
    s_sleep 2
    s_branch K2_WC3
K2_WC3D:
    ds_read_b128 v[92:95], v6 offset:16384
    s_mov_b64 exec, s[24:25]
    ds_read_b128 v[108:111], v7 offset:15360
    ds_read_b128 v[112:115], v7 offset:15872
    s_mov_b64 exec, -1
    s_waitcnt lgkmcnt(3)
    v_mfma_f32_32x32x16_bf16 v[48:63], v[88:91], v[8:11], v[16:31]
    v_exp_f32 v32, v32
    v_exp_f32 v33, v33
    v_exp_f32 v34, v34
    v_exp_f32 v35, v35
    v_exp_f32 v36, v36
    v_exp_f32 v37, v37
    v_exp_f32 v38, v38
    v_exp_f32 v39, v39
    v_cvt_pk_bf16_f32 v80, v32, v33
    v_cvt_pk_bf16_f32 v81, v34, v35
    v_cvt_pk_bf16_f32 v82, v36, v37
    v_cvt_pk_bf16_f32 v83, v38, v39
    s_nop 1
    v_mfma_f32_32x32x16_bf16 v[64:79], v[100:103], v[80:83], v[64:79]
    v_exp_f32 v40, v40
    v_exp_f32 v41, v41
    v_exp_f32 v42, v42
    v_exp_f32 v43, v43
    v_exp_f32 v44, v44
    v_exp_f32 v45, v45
    v_exp_f32 v46, v46
    v_exp_f32 v47, v47
    v_cvt_pk_bf16_f32 v84, v40, v41
    v_cvt_pk_bf16_f32 v85, v42, v43
    v_cvt_pk_bf16_f32 v86, v44, v45
    v_cvt_pk_bf16_f32 v87, v46, v47
    s_nop 1
    v_mfma_f32_32x32x16_bf16 v[64:79], v[104:107], v[84:87], v[64:79]
    ds_read_b128 v[96:99], v6 offset:17408
    s_mov_b64 exec, s[24:25]
    ds_read_b128 v[100:103], v7 offset:16384
    ds_read_b128 v[104:107], v7 offset:16896
    s_mov_b64 exec, -1
    s_waitcnt lgkmcnt(3)
    v_mfma_f32_32x32x16_bf16 v[32:47], v[92:95], v[8:11], v[16:31]
    v_exp_f32 v48, v48
    v_exp_f32 v49, v49
    v_exp_f32 v50, v50
    v_exp_f32 v51, v51
    v_exp_f32 v52, v52
    v_exp_f32 v53, v53
    v_exp_f32 v54, v54
    v_exp_f32 v55, v55
    v_cvt_pk_bf16_f32 v80, v48, v49
    v_cvt_pk_bf16_f32 v81, v50, v51
    v_cvt_pk_bf16_f32 v82, v52, v53
    v_cvt_pk_bf16_f32 v83, v54, v55
    s_nop 1
    v_mfma_f32_32x32x16_bf16 v[64:79], v[108:111], v[80:83], v[64:79]
    v_exp_f32 v56, v56
    v_exp_f32 v57, v57
    v_exp_f32 v58, v58
    v_exp_f32 v59, v59
    v_exp_f32 v60, v60
    v_exp_f32 v61, v61
    v_exp_f32 v62, v62
    v_exp_f32 v63, v63
    v_cvt_pk_bf16_f32 v84, v56, v57
    v_cvt_pk_bf16_f32 v85, v58, v59
    v_cvt_pk_bf16_f32 v86, v60, v61
    v_cvt_pk_bf16_f32 v87, v62, v63
    s_nop 1
    v_mfma_f32_32x32x16_bf16 v[64:79], v[112:115], v[84:87], v[64:79]
    ds_read_b128 v[88:91], v6 offset:18432
    s_mov_b64 exec, s[24:25]
    ds_read_b128 v[108:111], v7 offset:17408
    ds_read_b128 v[112:115], v7 offset:17920
    s_mov_b64 exec, -1
    s_waitcnt lgkmcnt(3)
    v_mfma_f32_32x32x16_bf16 v[48:63], v[96:99], v[8:11], v[16:31]
    v_exp_f32 v32, v32
    v_exp_f32 v33, v33
    v_exp_f32 v34, v34
    v_exp_f32 v35, v35
    v_exp_f32 v36, v36
    v_exp_f32 v37, v37
    v_exp_f32 v38, v38
    v_exp_f32 v39, v39
    v_cvt_pk_bf16_f32 v80, v32, v33
    v_cvt_pk_bf16_f32 v81, v34, v35
    v_cvt_pk_bf16_f32 v82, v36, v37
    v_cvt_pk_bf16_f32 v83, v38, v39
    s_nop 1
    v_mfma_f32_32x32x16_bf16 v[64:79], v[100:103], v[80:83], v[64:79]
    v_exp_f32 v40, v40
    v_exp_f32 v41, v41
    v_exp_f32 v42, v42
    v_exp_f32 v43, v43
    v_exp_f32 v44, v44
    v_exp_f32 v45, v45
    v_exp_f32 v46, v46
    v_exp_f32 v47, v47
    v_cvt_pk_bf16_f32 v84, v40, v41
    v_cvt_pk_bf16_f32 v85, v42, v43
    v_cvt_pk_bf16_f32 v86, v44, v45
    v_cvt_pk_bf16_f32 v87, v46, v47
    s_nop 1
    v_mfma_f32_32x32x16_bf16 v[64:79], v[104:107], v[84:87], v[64:79]
    ds_read_b128 v[92:95], v6 offset:19456
    s_mov_b64 exec, s[24:25]
    ds_read_b128 v[100:103], v7 offset:18432
    ds_read_b128 v[104:107], v7 offset:18944
    s_mov_b64 exec, -1
    s_waitcnt lgkmcnt(3)
    v_mfma_f32_32x32x16_bf16 v[32:47], v[88:91], v[8:11], v[16:31]
    v_exp_f32 v48, v48
    v_exp_f32 v49, v49
    v_exp_f32 v50, v50
    v_exp_f32 v51, v51
    v_exp_f32 v52, v52
    v_exp_f32 v53, v53
    v_exp_f32 v54, v54
    v_exp_f32 v55, v55
    v_cvt_pk_bf16_f32 v80, v48, v49
    v_cvt_pk_bf16_f32 v81, v50, v51
    v_cvt_pk_bf16_f32 v82, v52, v53
    v_cvt_pk_bf16_f32 v83, v54, v55
    s_nop 1
    v_mfma_f32_32x32x16_bf16 v[64:79], v[108:111], v[80:83], v[64:79]
    v_exp_f32 v56, v56
    v_exp_f32 v57, v57
    v_exp_f32 v58, v58
    v_exp_f32 v59, v59
    v_exp_f32 v60, v60
    v_exp_f32 v61, v61
    v_exp_f32 v62, v62
    v_exp_f32 v63, v63
    v_cvt_pk_bf16_f32 v84, v56, v57
    v_cvt_pk_bf16_f32 v85, v58, v59
    v_cvt_pk_bf16_f32 v86, v60, v61
    v_cvt_pk_bf16_f32 v87, v62, v63
    s_nop 1
    v_mfma_f32_32x32x16_bf16 v[64:79], v[112:115], v[84:87], v[64:79]
    ds_read_b128 v[96:99], v6 offset:20480
    s_mov_b64 exec, s[24:25]
    ds_read_b128 v[108:111], v7 offset:19456
    ds_read_b128 v[112:115], v7 offset:19968
    s_mov_b64 exec, -1
    s_waitcnt lgkmcnt(3)
    v_mfma_f32_32x32x16_bf16 v[48:63], v[92:95], v[8:11], v[16:31]
    v_exp_f32 v32, v32
    v_exp_f32 v33, v33
    v_exp_f32 v34, v34
    v_exp_f32 v35, v35
    v_exp_f32 v36, v36
    v_exp_f32 v37, v37
    v_exp_f32 v38, v38
    v_exp_f32 v39, v39
    v_cvt_pk_bf16_f32 v80, v32, v33
    v_cvt_pk_bf16_f32 v81, v34, v35
    v_cvt_pk_bf16_f32 v82, v36, v37
    v_cvt_pk_bf16_f32 v83, v38, v39
    s_nop 1
    v_mfma_f32_32x32x16_bf16 v[64:79], v[100:103], v[80:83], v[64:79]
    v_exp_f32 v40, v40
    v_exp_f32 v41, v41
    v_exp_f32 v42, v42
    v_exp_f32 v43, v43
    v_exp_f32 v44, v44
    v_exp_f32 v45, v45
    v_exp_f32 v46, v46
    v_exp_f32 v47, v47
    v_cvt_pk_bf16_f32 v84, v40, v41
    v_cvt_pk_bf16_f32 v85, v42, v43
    v_cvt_pk_bf16_f32 v86, v44, v45
    v_cvt_pk_bf16_f32 v87, v46, v47
    s_nop 1
    v_mfma_f32_32x32x16_bf16 v[64:79], v[104:107], v[84:87], v[64:79]
    ds_read_b128 v[88:91], v6 offset:21504
    s_mov_b64 exec, s[24:25]
    ds_read_b128 v[100:103], v7 offset:20480
    ds_read_b128 v[104:107], v7 offset:20992
    s_mov_b64 exec, -1
    s_waitcnt lgkmcnt(3)
    v_mfma_f32_32x32x16_bf16 v[32:47], v[96:99], v[8:11], v[16:31]
    v_exp_f32 v48, v48
    v_exp_f32 v49, v49
    v_exp_f32 v50, v50
    v_exp_f32 v51, v51
    v_exp_f32 v52, v52
    v_exp_f32 v53, v53
    v_exp_f32 v54, v54
    v_exp_f32 v55, v55
    v_cvt_pk_bf16_f32 v80, v48, v49
    v_cvt_pk_bf16_f32 v81, v50, v51
    v_cvt_pk_bf16_f32 v82, v52, v53
    v_cvt_pk_bf16_f32 v83, v54, v55
    s_nop 1
    v_mfma_f32_32x32x16_bf16 v[64:79], v[108:111], v[80:83], v[64:79]
    v_exp_f32 v56, v56
    v_exp_f32 v57, v57
    v_exp_f32 v58, v58
    v_exp_f32 v59, v59
    v_exp_f32 v60, v60
    v_exp_f32 v61, v61
    v_exp_f32 v62, v62
    v_exp_f32 v63, v63
    v_cvt_pk_bf16_f32 v84, v56, v57
    v_cvt_pk_bf16_f32 v85, v58, v59
    v_cvt_pk_bf16_f32 v86, v60, v61
    v_cvt_pk_bf16_f32 v87, v62, v63
    s_nop 1
    v_mfma_f32_32x32x16_bf16 v[64:79], v[112:115], v[84:87], v[64:79]
    ds_read_b128 v[92:95], v6 offset:22528
    s_mov_b64 exec, s[24:25]
    ds_read_b128 v[108:111], v7 offset:21504
    ds_read_b128 v[112:115], v7 offset:22016
    s_mov_b64 exec, -1
    s_waitcnt lgkmcnt(3)
    v_mfma_f32_32x32x16_bf16 v[48:63], v[88:91], v[8:11], v[16:31]
    v_exp_f32 v32, v32
    v_exp_f32 v33, v33
    v_exp_f32 v34, v34
    v_exp_f32 v35, v35
    v_exp_f32 v36, v36
    v_exp_f32 v37, v37
    v_exp_f32 v38, v38
    v_exp_f32 v39, v39
    v_cvt_pk_bf16_f32 v80, v32, v33
    v_cvt_pk_bf16_f32 v81, v34, v35
    v_cvt_pk_bf16_f32 v82, v36, v37
    v_cvt_pk_bf16_f32 v83, v38, v39
    s_nop 1
    v_mfma_f32_32x32x16_bf16 v[64:79], v[100:103], v[80:83], v[64:79]
    v_exp_f32 v40, v40
    v_exp_f32 v41, v41
    v_exp_f32 v42, v42
    v_exp_f32 v43, v43
    v_exp_f32 v44, v44
    v_exp_f32 v45, v45
    v_exp_f32 v46, v46
    v_exp_f32 v47, v47
    v_cvt_pk_bf16_f32 v84, v40, v41
    v_cvt_pk_bf16_f32 v85, v42, v43
    v_cvt_pk_bf16_f32 v86, v44, v45
    v_cvt_pk_bf16_f32 v87, v46, v47
    s_nop 1
    v_mfma_f32_32x32x16_bf16 v[64:79], v[104:107], v[84:87], v[64:79]
    ds_read_b128 v[96:99], v6 offset:23552
    s_mov_b64 exec, s[24:25]
    ds_read_b128 v[100:103], v7 offset:22528
    ds_read_b128 v[104:107], v7 offset:23040
    s_mov_b64 exec, -1
    s_waitcnt lgkmcnt(3)
    v_mfma_f32_32x32x16_bf16 v[32:47], v[92:95], v[8:11], v[16:31]
    v_exp_f32 v48, v48
    v_exp_f32 v49, v49
    v_exp_f32 v50, v50
    v_exp_f32 v51, v51
    v_exp_f32 v52, v52
    v_exp_f32 v53, v53
    v_exp_f32 v54, v54
    v_exp_f32 v55, v55
    v_cvt_pk_bf16_f32 v80, v48, v49
    v_cvt_pk_bf16_f32 v81, v50, v51
    v_cvt_pk_bf16_f32 v82, v52, v53
    v_cvt_pk_bf16_f32 v83, v54, v55
    s_nop 1
    v_mfma_f32_32x32x16_bf16 v[64:79], v[108:111], v[80:83], v[64:79]
    v_exp_f32 v56, v56
    v_exp_f32 v57, v57
    v_exp_f32 v58, v58
    v_exp_f32 v59, v59
    v_exp_f32 v60, v60
    v_exp_f32 v61, v61
    v_exp_f32 v62, v62
    v_exp_f32 v63, v63
    v_cvt_pk_bf16_f32 v84, v56, v57
    v_cvt_pk_bf16_f32 v85, v58, v59
    v_cvt_pk_bf16_f32 v86, v60, v61
    v_cvt_pk_bf16_f32 v87, v62, v63
    s_nop 1
    v_mfma_f32_32x32x16_bf16 v[64:79], v[112:115], v[84:87], v[64:79]
    ds_read_b128 v[88:91], v6 offset:24576
    s_mov_b64 exec, s[24:25]
    ds_read_b128 v[108:111], v7 offset:23552
    ds_read_b128 v[112:115], v7 offset:24064
    s_mov_b64 exec, -1
    s_waitcnt lgkmcnt(3)
    v_mfma_f32_32x32x16_bf16 v[48:63], v[96:99], v[8:11], v[16:31]
    v_exp_f32 v32, v32
    v_exp_f32 v33, v33
    v_exp_f32 v34, v34
    v_exp_f32 v35, v35
    v_exp_f32 v36, v36
    v_exp_f32 v37, v37
    v_exp_f32 v38, v38
    v_exp_f32 v39, v39
    v_cvt_pk_bf16_f32 v80, v32, v33
    v_cvt_pk_bf16_f32 v81, v34, v35
    v_cvt_pk_bf16_f32 v82, v36, v37
    v_cvt_pk_bf16_f32 v83, v38, v39
    s_nop 1
    v_mfma_f32_32x32x16_bf16 v[64:79], v[100:103], v[80:83], v[64:79]
    v_exp_f32 v40, v40
    v_exp_f32 v41, v41
    v_exp_f32 v42, v42
    v_exp_f32 v43, v43
    v_exp_f32 v44, v44
    v_exp_f32 v45, v45
    v_exp_f32 v46, v46
    v_exp_f32 v47, v47
    v_cvt_pk_bf16_f32 v84, v40, v41
    v_cvt_pk_bf16_f32 v85, v42, v43
    v_cvt_pk_bf16_f32 v86, v44, v45
    v_cvt_pk_bf16_f32 v87, v46, v47
    s_nop 1
    v_mfma_f32_32x32x16_bf16 v[64:79], v[104:107], v[84:87], v[64:79]
    ds_read_b128 v[92:95], v6 offset:25600
    s_mov_b64 exec, s[24:25]
    ds_read_b128 v[100:103], v7 offset:24576
    ds_read_b128 v[104:107], v7 offset:25088
    s_mov_b64 exec, -1
    s_waitcnt lgkmcnt(3)
    v_mfma_f32_32x32x16_bf16 v[32:47], v[88:91], v[8:11], v[16:31]
    v_exp_f32 v48, v48
    v_exp_f32 v49, v49
    v_exp_f32 v50, v50
    v_exp_f32 v51, v51
    v_exp_f32 v52, v52
    v_exp_f32 v53, v53
    v_exp_f32 v54, v54
    v_exp_f32 v55, v55
    v_cvt_pk_bf16_f32 v80, v48, v49
    v_cvt_pk_bf16_f32 v81, v50, v51
    v_cvt_pk_bf16_f32 v82, v52, v53
    v_cvt_pk_bf16_f32 v83, v54, v55
    s_nop 1
    v_mfma_f32_32x32x16_bf16 v[64:79], v[108:111], v[80:83], v[64:79]
    v_exp_f32 v56, v56
    v_exp_f32 v57, v57
    v_exp_f32 v58, v58
    v_exp_f32 v59, v59
    v_exp_f32 v60, v60
    v_exp_f32 v61, v61
    v_exp_f32 v62, v62
    v_exp_f32 v63, v63
    v_cvt_pk_bf16_f32 v84, v56, v57
    v_cvt_pk_bf16_f32 v85, v58, v59
    v_cvt_pk_bf16_f32 v86, v60, v61
    v_cvt_pk_bf16_f32 v87, v62, v63
    s_nop 1
    v_mfma_f32_32x32x16_bf16 v[64:79], v[112:115], v[84:87], v[64:79]
    ds_read_b128 v[96:99], v6 offset:26624
    s_mov_b64 exec, s[24:25]
    ds_read_b128 v[108:111], v7 offset:25600
    ds_read_b128 v[112:115], v7 offset:26112
    s_mov_b64 exec, -1
    s_waitcnt lgkmcnt(3)
    v_mfma_f32_32x32x16_bf16 v[48:63], v[92:95], v[8:11], v[16:31]
    v_exp_f32 v32, v32
    v_exp_f32 v33, v33
    v_exp_f32 v34, v34
    v_exp_f32 v35, v35
    v_exp_f32 v36, v36
    v_exp_f32 v37, v37
    v_exp_f32 v38, v38
    v_exp_f32 v39, v39
    v_cvt_pk_bf16_f32 v80, v32, v33
    v_cvt_pk_bf16_f32 v81, v34, v35
    v_cvt_pk_bf16_f32 v82, v36, v37
    v_cvt_pk_bf16_f32 v83, v38, v39
    s_nop 1
    v_mfma_f32_32x32x16_bf16 v[64:79], v[100:103], v[80:83], v[64:79]
    v_exp_f32 v40, v40
    v_exp_f32 v41, v41
    v_exp_f32 v42, v42
    v_exp_f32 v43, v43
    v_exp_f32 v44, v44
    v_exp_f32 v45, v45
    v_exp_f32 v46, v46
    v_exp_f32 v47, v47
    v_cvt_pk_bf16_f32 v84, v40, v41
    v_cvt_pk_bf16_f32 v85, v42, v43
    v_cvt_pk_bf16_f32 v86, v44, v45
    v_cvt_pk_bf16_f32 v87, v46, v47
    s_nop 1
    v_mfma_f32_32x32x16_bf16 v[64:79], v[104:107], v[84:87], v[64:79]
    ds_read_b128 v[88:91], v6 offset:27648
    s_mov_b64 exec, s[24:25]
    ds_read_b128 v[100:103], v7 offset:26624
    ds_read_b128 v[104:107], v7 offset:27136
    s_mov_b64 exec, -1
    s_waitcnt lgkmcnt(3)
    v_mfma_f32_32x32x16_bf16 v[32:47], v[96:99], v[8:11], v[16:31]
    v_exp_f32 v48, v48
    v_exp_f32 v49, v49
    v_exp_f32 v50, v50
    v_exp_f32 v51, v51
    v_exp_f32 v52, v52
    v_exp_f32 v53, v53
    v_exp_f32 v54, v54
    v_exp_f32 v55, v55
    v_cvt_pk_bf16_f32 v80, v48, v49
    v_cvt_pk_bf16_f32 v81, v50, v51
    v_cvt_pk_bf16_f32 v82, v52, v53
    v_cvt_pk_bf16_f32 v83, v54, v55
    s_nop 1
    v_mfma_f32_32x32x16_bf16 v[64:79], v[108:111], v[80:83], v[64:79]
    v_exp_f32 v56, v56
    v_exp_f32 v57, v57
    v_exp_f32 v58, v58
    v_exp_f32 v59, v59
    v_exp_f32 v60, v60
    v_exp_f32 v61, v61
    v_exp_f32 v62, v62
    v_exp_f32 v63, v63
    v_cvt_pk_bf16_f32 v84, v56, v57
    v_cvt_pk_bf16_f32 v85, v58, v59
    v_cvt_pk_bf16_f32 v86, v60, v61
    v_cvt_pk_bf16_f32 v87, v62, v63
    s_nop 1
    v_mfma_f32_32x32x16_bf16 v[64:79], v[112:115], v[84:87], v[64:79]
    ds_read_b128 v[92:95], v6 offset:28672
    s_mov_b64 exec, s[24:25]
    ds_read_b128 v[108:111], v7 offset:27648
    ds_read_b128 v[112:115], v7 offset:28160
    s_mov_b64 exec, -1
    s_waitcnt lgkmcnt(3)
    v_mfma_f32_32x32x16_bf16 v[48:63], v[88:91], v[8:11], v[16:31]
    v_exp_f32 v32, v32
    v_exp_f32 v33, v33
    v_exp_f32 v34, v34
    v_exp_f32 v35, v35
    v_exp_f32 v36, v36
    v_exp_f32 v37, v37
    v_exp_f32 v38, v38
    v_exp_f32 v39, v39
    v_cvt_pk_bf16_f32 v80, v32, v33
    v_cvt_pk_bf16_f32 v81, v34, v35
    v_cvt_pk_bf16_f32 v82, v36, v37
    v_cvt_pk_bf16_f32 v83, v38, v39
    s_nop 1
    v_mfma_f32_32x32x16_bf16 v[64:79], v[100:103], v[80:83], v[64:79]
    v_exp_f32 v40, v40
    v_exp_f32 v41, v41
    v_exp_f32 v42, v42
    v_exp_f32 v43, v43
    v_exp_f32 v44, v44
    v_exp_f32 v45, v45
    v_exp_f32 v46, v46
    v_exp_f32 v47, v47
    v_cvt_pk_bf16_f32 v84, v40, v41
    v_cvt_pk_bf16_f32 v85, v42, v43
    v_cvt_pk_bf16_f32 v86, v44, v45
    v_cvt_pk_bf16_f32 v87, v46, v47
    s_nop 1
    v_mfma_f32_32x32x16_bf16 v[64:79], v[104:107], v[84:87], v[64:79]
    ds_read_b128 v[96:99], v6 offset:29696
    s_mov_b64 exec, s[24:25]
    ds_read_b128 v[100:103], v7 offset:28672
    ds_read_b128 v[104:107], v7 offset:29184
    s_mov_b64 exec, -1
    s_waitcnt lgkmcnt(3)
    v_mfma_f32_32x32x16_bf16 v[32:47], v[92:95], v[8:11], v[16:31]
    v_exp_f32 v48, v48
    v_exp_f32 v49, v49
    v_exp_f32 v50, v50
    v_exp_f32 v51, v51
    v_exp_f32 v52, v52
    v_exp_f32 v53, v53
    v_exp_f32 v54, v54
    v_exp_f32 v55, v55
    v_cvt_pk_bf16_f32 v80, v48, v49
    v_cvt_pk_bf16_f32 v81, v50, v51
    v_cvt_pk_bf16_f32 v82, v52, v53
    v_cvt_pk_bf16_f32 v83, v54, v55
    s_nop 1
    v_mfma_f32_32x32x16_bf16 v[64:79], v[108:111], v[80:83], v[64:79]
    v_exp_f32 v56, v56
    v_exp_f32 v57, v57
    v_exp_f32 v58, v58
    v_exp_f32 v59, v59
    v_exp_f32 v60, v60
    v_exp_f32 v61, v61
    v_exp_f32 v62, v62
    v_exp_f32 v63, v63
    v_cvt_pk_bf16_f32 v84, v56, v57
    v_cvt_pk_bf16_f32 v85, v58, v59
    v_cvt_pk_bf16_f32 v86, v60, v61
    v_cvt_pk_bf16_f32 v87, v62, v63
    s_nop 1
    v_mfma_f32_32x32x16_bf16 v[64:79], v[112:115], v[84:87], v[64:79]
    ds_read_b128 v[88:91], v6 offset:30720
    s_mov_b64 exec, s[24:25]
    ds_read_b128 v[108:111], v7 offset:29696
    ds_read_b128 v[112:115], v7 offset:30208
    s_mov_b64 exec, -1
    s_waitcnt lgkmcnt(3)
    v_mfma_f32_32x32x16_bf16 v[48:63], v[96:99], v[8:11], v[16:31]
    v_exp_f32 v32, v32
    v_exp_f32 v33, v33
    v_exp_f32 v34, v34
    v_exp_f32 v35, v35
    v_exp_f32 v36, v36
    v_exp_f32 v37, v37
    v_exp_f32 v38, v38
    v_exp_f32 v39, v39
    v_cvt_pk_bf16_f32 v80, v32, v33
    v_cvt_pk_bf16_f32 v81, v34, v35
    v_cvt_pk_bf16_f32 v82, v36, v37
    v_cvt_pk_bf16_f32 v83, v38, v39
    s_nop 1
    v_mfma_f32_32x32x16_bf16 v[64:79], v[100:103], v[80:83], v[64:79]
    v_exp_f32 v40, v40
    v_exp_f32 v41, v41
    v_exp_f32 v42, v42
    v_exp_f32 v43, v43
    v_exp_f32 v44, v44
    v_exp_f32 v45, v45
    v_exp_f32 v46, v46
    v_exp_f32 v47, v47
    v_cvt_pk_bf16_f32 v84, v40, v41
    v_cvt_pk_bf16_f32 v85, v42, v43
    v_cvt_pk_bf16_f32 v86, v44, v45
    v_cvt_pk_bf16_f32 v87, v46, v47
    s_nop 1
    v_mfma_f32_32x32x16_bf16 v[64:79], v[104:107], v[84:87], v[64:79]
    ds_read_b128 v[92:95], v6 offset:31744
    s_mov_b64 exec, s[24:25]
    ds_read_b128 v[100:103], v7 offset:30720
    ds_read_b128 v[104:107], v7 offset:31232
    s_mov_b64 exec, -1
    s_waitcnt lgkmcnt(3)
    v_mfma_f32_32x32x16_bf16 v[32:47], v[88:91], v[8:11], v[16:31]
    v_exp_f32 v48, v48
    v_exp_f32 v49, v49
    v_exp_f32 v50, v50
    v_exp_f32 v51, v51
    v_exp_f32 v52, v52
    v_exp_f32 v53, v53
    v_exp_f32 v54, v54
    v_exp_f32 v55, v55
    v_cvt_pk_bf16_f32 v80, v48, v49
    v_cvt_pk_bf16_f32 v81, v50, v51
    v_cvt_pk_bf16_f32 v82, v52, v53
    v_cvt_pk_bf16_f32 v83, v54, v55
    s_nop 1
    v_mfma_f32_32x32x16_bf16 v[64:79], v[108:111], v[80:83], v[64:79]
    v_exp_f32 v56, v56
    v_exp_f32 v57, v57
    v_exp_f32 v58, v58
    v_exp_f32 v59, v59
    v_exp_f32 v60, v60
    v_exp_f32 v61, v61
    v_exp_f32 v62, v62
    v_exp_f32 v63, v63
    v_cvt_pk_bf16_f32 v84, v56, v57
    v_cvt_pk_bf16_f32 v85, v58, v59
    v_cvt_pk_bf16_f32 v86, v60, v61
    v_cvt_pk_bf16_f32 v87, v62, v63
    s_nop 1
    v_mfma_f32_32x32x16_bf16 v[64:79], v[112:115], v[84:87], v[64:79]
K2_WC4:
    ds_read_b32 v2, v13 offset:12
    s_waitcnt lgkmcnt(0)
    v_readfirstlane_b32 s47, v2
    s_nop 3
    s_cmp_ge_u32 s47, 4
    s_cbranch_scc1 K2_WC4D
    s_sleep 2
    s_branch K2_WC4
K2_WC4D:
    ds_read_b128 v[96:99], v6 offset:32768
    s_mov_b64 exec, s[24:25]
    ds_read_b128 v[108:111], v7 offset:31744
    ds_read_b128 v[112:115], v7 offset:32256
    s_mov_b64 exec, -1
    s_waitcnt lgkmcnt(3)
    v_mfma_f32_32x32x16_bf16 v[48:63], v[92:95], v[8:11], v[16:31]
    v_exp_f32 v32, v32
    v_exp_f32 v33, v33
    v_exp_f32 v34, v34
    v_exp_f32 v35, v35
    v_exp_f32 v36, v36
    v_exp_f32 v37, v37
    v_exp_f32 v38, v38
    v_exp_f32 v39, v39
    v_cvt_pk_bf16_f32 v80, v32, v33
    v_cvt_pk_bf16_f32 v81, v34, v35
    v_cvt_pk_bf16_f32 v82, v36, v37
    v_cvt_pk_bf16_f32 v83, v38, v39
    s_nop 1
    v_mfma_f32_32x32x16_bf16 v[64:79], v[100:103], v[80:83], v[64:79]
    v_exp_f32 v40, v40
    v_exp_f32 v41, v41
    v_exp_f32 v42, v42
    v_exp_f32 v43, v43
    v_exp_f32 v44, v44
    v_exp_f32 v45, v45
    v_exp_f32 v46, v46
    v_exp_f32 v47, v47
    v_cvt_pk_bf16_f32 v84, v40, v41
    v_cvt_pk_bf16_f32 v85, v42, v43
    v_cvt_pk_bf16_f32 v86, v44, v45
    v_cvt_pk_bf16_f32 v87, v46, v47
    s_nop 1
    v_mfma_f32_32x32x16_bf16 v[64:79], v[104:107], v[84:87], v[64:79]
    ds_read_b128 v[88:91], v6 offset:33792
    s_mov_b64 exec, s[24:25]
    ds_read_b128 v[100:103], v7 offset:32768
    ds_read_b128 v[104:107], v7 offset:33280
    s_mov_b64 exec, -1
    s_waitcnt lgkmcnt(3)
    v_mfma_f32_32x32x16_bf16 v[32:47], v[96:99], v[8:11], v[16:31]
    v_exp_f32 v48, v48
    v_exp_f32 v49, v49
    v_exp_f32 v50, v50
    v_exp_f32 v51, v51
    v_exp_f32 v52, v52
    v_exp_f32 v53, v53
    v_exp_f32 v54, v54
    v_exp_f32 v55, v55
    v_cvt_pk_bf16_f32 v80, v48, v49
    v_cvt_pk_bf16_f32 v81, v50, v51
    v_cvt_pk_bf16_f32 v82, v52, v53
    v_cvt_pk_bf16_f32 v83, v54, v55
    s_nop 1
    v_mfma_f32_32x32x16_bf16 v[64:79], v[108:111], v[80:83], v[64:79]
    v_exp_f32 v56, v56
    v_exp_f32 v57, v57
    v_exp_f32 v58, v58
    v_exp_f32 v59, v59
    v_exp_f32 v60, v60
    v_exp_f32 v61, v61
    v_exp_f32 v62, v62
    v_exp_f32 v63, v63
    v_cvt_pk_bf16_f32 v84, v56, v57
    v_cvt_pk_bf16_f32 v85, v58, v59
    v_cvt_pk_bf16_f32 v86, v60, v61
    v_cvt_pk_bf16_f32 v87, v62, v63
    s_nop 1
    v_mfma_f32_32x32x16_bf16 v[64:79], v[112:115], v[84:87], v[64:79]
    ds_read_b128 v[92:95], v6 offset:34816
    s_mov_b64 exec, s[24:25]
    ds_read_b128 v[108:111], v7 offset:33792
    ds_read_b128 v[112:115], v7 offset:34304
    s_mov_b64 exec, -1
    s_waitcnt lgkmcnt(3)
    v_mfma_f32_32x32x16_bf16 v[48:63], v[88:91], v[8:11], v[16:31]
    v_exp_f32 v32, v32
    v_exp_f32 v33, v33
    v_exp_f32 v34, v34
    v_exp_f32 v35, v35
    v_exp_f32 v36, v36
    v_exp_f32 v37, v37
    v_exp_f32 v38, v38
    v_exp_f32 v39, v39
    v_cvt_pk_bf16_f32 v80, v32, v33
    v_cvt_pk_bf16_f32 v81, v34, v35
    v_cvt_pk_bf16_f32 v82, v36, v37
    v_cvt_pk_bf16_f32 v83, v38, v39
    s_nop 1
    v_mfma_f32_32x32x16_bf16 v[64:79], v[100:103], v[80:83], v[64:79]
    v_exp_f32 v40, v40
    v_exp_f32 v41, v41
    v_exp_f32 v42, v42
    v_exp_f32 v43, v43
    v_exp_f32 v44, v44
    v_exp_f32 v45, v45
    v_exp_f32 v46, v46
    v_exp_f32 v47, v47
    v_cvt_pk_bf16_f32 v84, v40, v41
    v_cvt_pk_bf16_f32 v85, v42, v43
    v_cvt_pk_bf16_f32 v86, v44, v45
    v_cvt_pk_bf16_f32 v87, v46, v47
    s_nop 1
    v_mfma_f32_32x32x16_bf16 v[64:79], v[104:107], v[84:87], v[64:79]
    ds_read_b128 v[96:99], v6 offset:35840
    s_mov_b64 exec, s[24:25]
    ds_read_b128 v[100:103], v7 offset:34816
    ds_read_b128 v[104:107], v7 offset:35328
    s_mov_b64 exec, -1
    s_waitcnt lgkmcnt(3)
    v_mfma_f32_32x32x16_bf16 v[32:47], v[92:95], v[8:11], v[16:31]
    v_exp_f32 v48, v48
    v_exp_f32 v49, v49
    v_exp_f32 v50, v50
    v_exp_f32 v51, v51
    v_exp_f32 v52, v52
    v_exp_f32 v53, v53
    v_exp_f32 v54, v54
    v_exp_f32 v55, v55
    v_cvt_pk_bf16_f32 v80, v48, v49
    v_cvt_pk_bf16_f32 v81, v50, v51
    v_cvt_pk_bf16_f32 v82, v52, v53
    v_cvt_pk_bf16_f32 v83, v54, v55
    s_nop 1
    v_mfma_f32_32x32x16_bf16 v[64:79], v[108:111], v[80:83], v[64:79]
    v_exp_f32 v56, v56
    v_exp_f32 v57, v57
    v_exp_f32 v58, v58
    v_exp_f32 v59, v59
    v_exp_f32 v60, v60
    v_exp_f32 v61, v61
    v_exp_f32 v62, v62
    v_exp_f32 v63, v63
    v_cvt_pk_bf16_f32 v84, v56, v57
    v_cvt_pk_bf16_f32 v85, v58, v59
    v_cvt_pk_bf16_f32 v86, v60, v61
    v_cvt_pk_bf16_f32 v87, v62, v63
    s_nop 1
    v_mfma_f32_32x32x16_bf16 v[64:79], v[112:115], v[84:87], v[64:79]
    ds_read_b128 v[88:91], v6 offset:36864
    s_mov_b64 exec, s[24:25]
    ds_read_b128 v[108:111], v7 offset:35840
    ds_read_b128 v[112:115], v7 offset:36352
    s_mov_b64 exec, -1
    s_waitcnt lgkmcnt(3)
    v_mfma_f32_32x32x16_bf16 v[48:63], v[96:99], v[8:11], v[16:31]
    v_exp_f32 v32, v32
    v_exp_f32 v33, v33
    v_exp_f32 v34, v34
    v_exp_f32 v35, v35
    v_exp_f32 v36, v36
    v_exp_f32 v37, v37
    v_exp_f32 v38, v38
    v_exp_f32 v39, v39
    v_cvt_pk_bf16_f32 v80, v32, v33
    v_cvt_pk_bf16_f32 v81, v34, v35
    v_cvt_pk_bf16_f32 v82, v36, v37
    v_cvt_pk_bf16_f32 v83, v38, v39
    s_nop 1
    v_mfma_f32_32x32x16_bf16 v[64:79], v[100:103], v[80:83], v[64:79]
    v_exp_f32 v40, v40
    v_exp_f32 v41, v41
    v_exp_f32 v42, v42
    v_exp_f32 v43, v43
    v_exp_f32 v44, v44
    v_exp_f32 v45, v45
    v_exp_f32 v46, v46
    v_exp_f32 v47, v47
    v_cvt_pk_bf16_f32 v84, v40, v41
    v_cvt_pk_bf16_f32 v85, v42, v43
    v_cvt_pk_bf16_f32 v86, v44, v45
    v_cvt_pk_bf16_f32 v87, v46, v47
    s_nop 1
    v_mfma_f32_32x32x16_bf16 v[64:79], v[104:107], v[84:87], v[64:79]
    ds_read_b128 v[92:95], v6 offset:37888
    s_mov_b64 exec, s[24:25]
    ds_read_b128 v[100:103], v7 offset:36864
    ds_read_b128 v[104:107], v7 offset:37376
    s_mov_b64 exec, -1
    s_waitcnt lgkmcnt(3)
    v_mfma_f32_32x32x16_bf16 v[32:47], v[88:91], v[8:11], v[16:31]
    v_exp_f32 v48, v48
    v_exp_f32 v49, v49
    v_exp_f32 v50, v50
    v_exp_f32 v51, v51
    v_exp_f32 v52, v52
    v_exp_f32 v53, v53
    v_exp_f32 v54, v54
    v_exp_f32 v55, v55
    v_cvt_pk_bf16_f32 v80, v48, v49
    v_cvt_pk_bf16_f32 v81, v50, v51
    v_cvt_pk_bf16_f32 v82, v52, v53
    v_cvt_pk_bf16_f32 v83, v54, v55
    s_nop 1
    v_mfma_f32_32x32x16_bf16 v[64:79], v[108:111], v[80:83], v[64:79]
    v_exp_f32 v56, v56
    v_exp_f32 v57, v57
    v_exp_f32 v58, v58
    v_exp_f32 v59, v59
    v_exp_f32 v60, v60
    v_exp_f32 v61, v61
    v_exp_f32 v62, v62
    v_exp_f32 v63, v63
    v_cvt_pk_bf16_f32 v84, v56, v57
    v_cvt_pk_bf16_f32 v85, v58, v59
    v_cvt_pk_bf16_f32 v86, v60, v61
    v_cvt_pk_bf16_f32 v87, v62, v63
    s_nop 1
    v_mfma_f32_32x32x16_bf16 v[64:79], v[112:115], v[84:87], v[64:79]
    ds_read_b128 v[96:99], v6 offset:38912
    s_mov_b64 exec, s[24:25]
    ds_read_b128 v[108:111], v7 offset:37888
    ds_read_b128 v[112:115], v7 offset:38400
    s_mov_b64 exec, -1
    s_waitcnt lgkmcnt(3)
    v_mfma_f32_32x32x16_bf16 v[48:63], v[92:95], v[8:11], v[16:31]
    v_exp_f32 v32, v32
    v_exp_f32 v33, v33
    v_exp_f32 v34, v34
    v_exp_f32 v35, v35
    v_exp_f32 v36, v36
    v_exp_f32 v37, v37
    v_exp_f32 v38, v38
    v_exp_f32 v39, v39
    v_cvt_pk_bf16_f32 v80, v32, v33
    v_cvt_pk_bf16_f32 v81, v34, v35
    v_cvt_pk_bf16_f32 v82, v36, v37
    v_cvt_pk_bf16_f32 v83, v38, v39
    s_nop 1
    v_mfma_f32_32x32x16_bf16 v[64:79], v[100:103], v[80:83], v[64:79]
    v_exp_f32 v40, v40
    v_exp_f32 v41, v41
    v_exp_f32 v42, v42
    v_exp_f32 v43, v43
    v_exp_f32 v44, v44
    v_exp_f32 v45, v45
    v_exp_f32 v46, v46
    v_exp_f32 v47, v47
    v_cvt_pk_bf16_f32 v84, v40, v41
    v_cvt_pk_bf16_f32 v85, v42, v43
    v_cvt_pk_bf16_f32 v86, v44, v45
    v_cvt_pk_bf16_f32 v87, v46, v47
    s_nop 1
    v_mfma_f32_32x32x16_bf16 v[64:79], v[104:107], v[84:87], v[64:79]
    ds_read_b128 v[88:91], v6 offset:39936
    s_mov_b64 exec, s[24:25]
    ds_read_b128 v[100:103], v7 offset:38912
    ds_read_b128 v[104:107], v7 offset:39424
    s_mov_b64 exec, -1
    s_waitcnt lgkmcnt(3)
    v_mfma_f32_32x32x16_bf16 v[32:47], v[96:99], v[8:11], v[16:31]
    v_exp_f32 v48, v48
    v_exp_f32 v49, v49
    v_exp_f32 v50, v50
    v_exp_f32 v51, v51
    v_exp_f32 v52, v52
    v_exp_f32 v53, v53
    v_exp_f32 v54, v54
    v_exp_f32 v55, v55
    v_cvt_pk_bf16_f32 v80, v48, v49
    v_cvt_pk_bf16_f32 v81, v50, v51
    v_cvt_pk_bf16_f32 v82, v52, v53
    v_cvt_pk_bf16_f32 v83, v54, v55
    s_nop 1
    v_mfma_f32_32x32x16_bf16 v[64:79], v[108:111], v[80:83], v[64:79]
    v_exp_f32 v56, v56
    v_exp_f32 v57, v57
    v_exp_f32 v58, v58
    v_exp_f32 v59, v59
    v_exp_f32 v60, v60
    v_exp_f32 v61, v61
    v_exp_f32 v62, v62
    v_exp_f32 v63, v63
    v_cvt_pk_bf16_f32 v84, v56, v57
    v_cvt_pk_bf16_f32 v85, v58, v59
    v_cvt_pk_bf16_f32 v86, v60, v61
    v_cvt_pk_bf16_f32 v87, v62, v63
    s_nop 1
    v_mfma_f32_32x32x16_bf16 v[64:79], v[112:115], v[84:87], v[64:79]
    ds_read_b128 v[92:95], v6 offset:40960
    s_mov_b64 exec, s[24:25]
    ds_read_b128 v[108:111], v7 offset:39936
    ds_read_b128 v[112:115], v7 offset:40448
    s_mov_b64 exec, -1
    s_waitcnt lgkmcnt(3)
    v_mfma_f32_32x32x16_bf16 v[48:63], v[88:91], v[8:11], v[16:31]
    v_exp_f32 v32, v32
    v_exp_f32 v33, v33
    v_exp_f32 v34, v34
    v_exp_f32 v35, v35
    v_exp_f32 v36, v36
    v_exp_f32 v37, v37
    v_exp_f32 v38, v38
    v_exp_f32 v39, v39
    v_cvt_pk_bf16_f32 v80, v32, v33
    v_cvt_pk_bf16_f32 v81, v34, v35
    v_cvt_pk_bf16_f32 v82, v36, v37
    v_cvt_pk_bf16_f32 v83, v38, v39
    s_nop 1
    v_mfma_f32_32x32x16_bf16 v[64:79], v[100:103], v[80:83], v[64:79]
    v_exp_f32 v40, v40
    v_exp_f32 v41, v41
    v_exp_f32 v42, v42
    v_exp_f32 v43, v43
    v_exp_f32 v44, v44
    v_exp_f32 v45, v45
    v_exp_f32 v46, v46
    v_exp_f32 v47, v47
    v_cvt_pk_bf16_f32 v84, v40, v41
    v_cvt_pk_bf16_f32 v85, v42, v43
    v_cvt_pk_bf16_f32 v86, v44, v45
    v_cvt_pk_bf16_f32 v87, v46, v47
    s_nop 1
    v_mfma_f32_32x32x16_bf16 v[64:79], v[104:107], v[84:87], v[64:79]
    ds_read_b128 v[96:99], v6 offset:41984
    s_mov_b64 exec, s[24:25]
    ds_read_b128 v[100:103], v7 offset:40960
    ds_read_b128 v[104:107], v7 offset:41472
    s_mov_b64 exec, -1
    s_waitcnt lgkmcnt(3)
    v_mfma_f32_32x32x16_bf16 v[32:47], v[92:95], v[8:11], v[16:31]
    v_exp_f32 v48, v48
    v_exp_f32 v49, v49
    v_exp_f32 v50, v50
    v_exp_f32 v51, v51
    v_exp_f32 v52, v52
    v_exp_f32 v53, v53
    v_exp_f32 v54, v54
    v_exp_f32 v55, v55
    v_cvt_pk_bf16_f32 v80, v48, v49
    v_cvt_pk_bf16_f32 v81, v50, v51
    v_cvt_pk_bf16_f32 v82, v52, v53
    v_cvt_pk_bf16_f32 v83, v54, v55
    s_nop 1
    v_mfma_f32_32x32x16_bf16 v[64:79], v[108:111], v[80:83], v[64:79]
    v_exp_f32 v56, v56
    v_exp_f32 v57, v57
    v_exp_f32 v58, v58
    v_exp_f32 v59, v59
    v_exp_f32 v60, v60
    v_exp_f32 v61, v61
    v_exp_f32 v62, v62
    v_exp_f32 v63, v63
    v_cvt_pk_bf16_f32 v84, v56, v57
    v_cvt_pk_bf16_f32 v85, v58, v59
    v_cvt_pk_bf16_f32 v86, v60, v61
    v_cvt_pk_bf16_f32 v87, v62, v63
    s_nop 1
    v_mfma_f32_32x32x16_bf16 v[64:79], v[112:115], v[84:87], v[64:79]
    ds_read_b128 v[88:91], v6 offset:43008
    s_mov_b64 exec, s[24:25]
    ds_read_b128 v[108:111], v7 offset:41984
    ds_read_b128 v[112:115], v7 offset:42496
    s_mov_b64 exec, -1
    s_waitcnt lgkmcnt(3)
    v_mfma_f32_32x32x16_bf16 v[48:63], v[96:99], v[8:11], v[16:31]
    v_exp_f32 v32, v32
    v_exp_f32 v33, v33
    v_exp_f32 v34, v34
    v_exp_f32 v35, v35
    v_exp_f32 v36, v36
    v_exp_f32 v37, v37
    v_exp_f32 v38, v38
    v_exp_f32 v39, v39
    v_cvt_pk_bf16_f32 v80, v32, v33
    v_cvt_pk_bf16_f32 v81, v34, v35
    v_cvt_pk_bf16_f32 v82, v36, v37
    v_cvt_pk_bf16_f32 v83, v38, v39
    s_nop 1
    v_mfma_f32_32x32x16_bf16 v[64:79], v[100:103], v[80:83], v[64:79]
    v_exp_f32 v40, v40
    v_exp_f32 v41, v41
    v_exp_f32 v42, v42
    v_exp_f32 v43, v43
    v_exp_f32 v44, v44
    v_exp_f32 v45, v45
    v_exp_f32 v46, v46
    v_exp_f32 v47, v47
    v_cvt_pk_bf16_f32 v84, v40, v41
    v_cvt_pk_bf16_f32 v85, v42, v43
    v_cvt_pk_bf16_f32 v86, v44, v45
    v_cvt_pk_bf16_f32 v87, v46, v47
    s_nop 1
    v_mfma_f32_32x32x16_bf16 v[64:79], v[104:107], v[84:87], v[64:79]
    ds_read_b128 v[92:95], v6 offset:44032
    s_mov_b64 exec, s[24:25]
    ds_read_b128 v[100:103], v7 offset:43008
    ds_read_b128 v[104:107], v7 offset:43520
    s_mov_b64 exec, -1
    s_waitcnt lgkmcnt(3)
    v_mfma_f32_32x32x16_bf16 v[32:47], v[88:91], v[8:11], v[16:31]
    v_exp_f32 v48, v48
    v_exp_f32 v49, v49
    v_exp_f32 v50, v50
    v_exp_f32 v51, v51
    v_exp_f32 v52, v52
    v_exp_f32 v53, v53
    v_exp_f32 v54, v54
    v_exp_f32 v55, v55
    v_cvt_pk_bf16_f32 v80, v48, v49
    v_cvt_pk_bf16_f32 v81, v50, v51
    v_cvt_pk_bf16_f32 v82, v52, v53
    v_cvt_pk_bf16_f32 v83, v54, v55
    s_nop 1
    v_mfma_f32_32x32x16_bf16 v[64:79], v[108:111], v[80:83], v[64:79]
    v_exp_f32 v56, v56
    v_exp_f32 v57, v57
    v_exp_f32 v58, v58
    v_exp_f32 v59, v59
    v_exp_f32 v60, v60
    v_exp_f32 v61, v61
    v_exp_f32 v62, v62
    v_exp_f32 v63, v63
    v_cvt_pk_bf16_f32 v84, v56, v57
    v_cvt_pk_bf16_f32 v85, v58, v59
    v_cvt_pk_bf16_f32 v86, v60, v61
    v_cvt_pk_bf16_f32 v87, v62, v63
    s_nop 1
    v_mfma_f32_32x32x16_bf16 v[64:79], v[112:115], v[84:87], v[64:79]
    ds_read_b128 v[96:99], v6 offset:45056
    s_mov_b64 exec, s[24:25]
    ds_read_b128 v[108:111], v7 offset:44032
    ds_read_b128 v[112:115], v7 offset:44544
    s_mov_b64 exec, -1
    s_waitcnt lgkmcnt(3)
    v_mfma_f32_32x32x16_bf16 v[48:63], v[92:95], v[8:11], v[16:31]
    v_exp_f32 v32, v32
    v_exp_f32 v33, v33
    v_exp_f32 v34, v34
    v_exp_f32 v35, v35
    v_exp_f32 v36, v36
    v_exp_f32 v37, v37
    v_exp_f32 v38, v38
    v_exp_f32 v39, v39
    v_cvt_pk_bf16_f32 v80, v32, v33
    v_cvt_pk_bf16_f32 v81, v34, v35
    v_cvt_pk_bf16_f32 v82, v36, v37
    v_cvt_pk_bf16_f32 v83, v38, v39
    s_nop 1
    v_mfma_f32_32x32x16_bf16 v[64:79], v[100:103], v[80:83], v[64:79]
    v_exp_f32 v40, v40
    v_exp_f32 v41, v41
    v_exp_f32 v42, v42
    v_exp_f32 v43, v43
    v_exp_f32 v44, v44
    v_exp_f32 v45, v45
    v_exp_f32 v46, v46
    v_exp_f32 v47, v47
    v_cvt_pk_bf16_f32 v84, v40, v41
    v_cvt_pk_bf16_f32 v85, v42, v43
    v_cvt_pk_bf16_f32 v86, v44, v45
    v_cvt_pk_bf16_f32 v87, v46, v47
    s_nop 1
    v_mfma_f32_32x32x16_bf16 v[64:79], v[104:107], v[84:87], v[64:79]
    ds_read_b128 v[88:91], v6 offset:46080
    s_mov_b64 exec, s[24:25]
    ds_read_b128 v[100:103], v7 offset:45056
    ds_read_b128 v[104:107], v7 offset:45568
    s_mov_b64 exec, -1
    s_waitcnt lgkmcnt(3)
    v_mfma_f32_32x32x16_bf16 v[32:47], v[96:99], v[8:11], v[16:31]
    v_exp_f32 v48, v48
    v_exp_f32 v49, v49
    v_exp_f32 v50, v50
    v_exp_f32 v51, v51
    v_exp_f32 v52, v52
    v_exp_f32 v53, v53
    v_exp_f32 v54, v54
    v_exp_f32 v55, v55
    v_cvt_pk_bf16_f32 v80, v48, v49
    v_cvt_pk_bf16_f32 v81, v50, v51
    v_cvt_pk_bf16_f32 v82, v52, v53
    v_cvt_pk_bf16_f32 v83, v54, v55
    s_nop 1
    v_mfma_f32_32x32x16_bf16 v[64:79], v[108:111], v[80:83], v[64:79]
    v_exp_f32 v56, v56
    v_exp_f32 v57, v57
    v_exp_f32 v58, v58
    v_exp_f32 v59, v59
    v_exp_f32 v60, v60
    v_exp_f32 v61, v61
    v_exp_f32 v62, v62
    v_exp_f32 v63, v63
    v_cvt_pk_bf16_f32 v84, v56, v57
    v_cvt_pk_bf16_f32 v85, v58, v59
    v_cvt_pk_bf16_f32 v86, v60, v61
    v_cvt_pk_bf16_f32 v87, v62, v63
    s_nop 1
    v_mfma_f32_32x32x16_bf16 v[64:79], v[112:115], v[84:87], v[64:79]
    ds_read_b128 v[92:95], v6 offset:47104
    s_mov_b64 exec, s[24:25]
    ds_read_b128 v[108:111], v7 offset:46080
    ds_read_b128 v[112:115], v7 offset:46592
    s_mov_b64 exec, -1
    s_waitcnt lgkmcnt(3)
    v_mfma_f32_32x32x16_bf16 v[48:63], v[88:91], v[8:11], v[16:31]
    v_exp_f32 v32, v32
    v_exp_f32 v33, v33
    v_exp_f32 v34, v34
    v_exp_f32 v35, v35
    v_exp_f32 v36, v36
    v_exp_f32 v37, v37
    v_exp_f32 v38, v38
    v_exp_f32 v39, v39
    v_cvt_pk_bf16_f32 v80, v32, v33
    v_cvt_pk_bf16_f32 v81, v34, v35
    v_cvt_pk_bf16_f32 v82, v36, v37
    v_cvt_pk_bf16_f32 v83, v38, v39
    s_nop 1
    v_mfma_f32_32x32x16_bf16 v[64:79], v[100:103], v[80:83], v[64:79]
    v_exp_f32 v40, v40
    v_exp_f32 v41, v41
    v_exp_f32 v42, v42
    v_exp_f32 v43, v43
    v_exp_f32 v44, v44
    v_exp_f32 v45, v45
    v_exp_f32 v46, v46
    v_exp_f32 v47, v47
    v_cvt_pk_bf16_f32 v84, v40, v41
    v_cvt_pk_bf16_f32 v85, v42, v43
    v_cvt_pk_bf16_f32 v86, v44, v45
    v_cvt_pk_bf16_f32 v87, v46, v47
    s_nop 1
    v_mfma_f32_32x32x16_bf16 v[64:79], v[104:107], v[84:87], v[64:79]
    ds_read_b128 v[96:99], v6 offset:48128
    s_mov_b64 exec, s[24:25]
    ds_read_b128 v[100:103], v7 offset:47104
    ds_read_b128 v[104:107], v7 offset:47616
    s_mov_b64 exec, -1
    s_waitcnt lgkmcnt(3)
    v_mfma_f32_32x32x16_bf16 v[32:47], v[92:95], v[8:11], v[16:31]
    v_exp_f32 v48, v48
    v_exp_f32 v49, v49
    v_exp_f32 v50, v50
    v_exp_f32 v51, v51
    v_exp_f32 v52, v52
    v_exp_f32 v53, v53
    v_exp_f32 v54, v54
    v_exp_f32 v55, v55
    v_cvt_pk_bf16_f32 v80, v48, v49
    v_cvt_pk_bf16_f32 v81, v50, v51
    v_cvt_pk_bf16_f32 v82, v52, v53
    v_cvt_pk_bf16_f32 v83, v54, v55
    s_nop 1
    v_mfma_f32_32x32x16_bf16 v[64:79], v[108:111], v[80:83], v[64:79]
    v_exp_f32 v56, v56
    v_exp_f32 v57, v57
    v_exp_f32 v58, v58
    v_exp_f32 v59, v59
    v_exp_f32 v60, v60
    v_exp_f32 v61, v61
    v_exp_f32 v62, v62
    v_exp_f32 v63, v63
    v_cvt_pk_bf16_f32 v84, v56, v57
    v_cvt_pk_bf16_f32 v85, v58, v59
    v_cvt_pk_bf16_f32 v86, v60, v61
    v_cvt_pk_bf16_f32 v87, v62, v63
    s_nop 1
    v_mfma_f32_32x32x16_bf16 v[64:79], v[112:115], v[84:87], v[64:79]
K2_WC5:
    ds_read_b32 v2, v13 offset:16
    s_waitcnt lgkmcnt(0)
    v_readfirstlane_b32 s47, v2
    s_nop 3
    s_cmp_ge_u32 s47, 4
    s_cbranch_scc1 K2_WC5D
    s_sleep 2
    s_branch K2_WC5
K2_WC5D:
    ds_read_b128 v[88:91], v6 offset:49152
    s_mov_b64 exec, s[24:25]
    ds_read_b128 v[108:111], v7 offset:48128
    ds_read_b128 v[112:115], v7 offset:48640
    s_mov_b64 exec, -1
    s_waitcnt lgkmcnt(3)
    v_mfma_f32_32x32x16_bf16 v[48:63], v[96:99], v[8:11], v[16:31]
    v_exp_f32 v32, v32
    v_exp_f32 v33, v33
    v_exp_f32 v34, v34
    v_exp_f32 v35, v35
    v_exp_f32 v36, v36
    v_exp_f32 v37, v37
    v_exp_f32 v38, v38
    v_exp_f32 v39, v39
    v_cvt_pk_bf16_f32 v80, v32, v33
    v_cvt_pk_bf16_f32 v81, v34, v35
    v_cvt_pk_bf16_f32 v82, v36, v37
    v_cvt_pk_bf16_f32 v83, v38, v39
    s_nop 1
    v_mfma_f32_32x32x16_bf16 v[64:79], v[100:103], v[80:83], v[64:79]
    v_exp_f32 v40, v40
    v_exp_f32 v41, v41
    v_exp_f32 v42, v42
    v_exp_f32 v43, v43
    v_exp_f32 v44, v44
    v_exp_f32 v45, v45
    v_exp_f32 v46, v46
    v_exp_f32 v47, v47
    v_cvt_pk_bf16_f32 v84, v40, v41
    v_cvt_pk_bf16_f32 v85, v42, v43
    v_cvt_pk_bf16_f32 v86, v44, v45
    v_cvt_pk_bf16_f32 v87, v46, v47
    s_nop 1
    v_mfma_f32_32x32x16_bf16 v[64:79], v[104:107], v[84:87], v[64:79]
    ds_read_b128 v[92:95], v6 offset:50176
    s_mov_b64 exec, s[24:25]
    ds_read_b128 v[100:103], v7 offset:49152
    ds_read_b128 v[104:107], v7 offset:49664
    s_mov_b64 exec, -1
    s_waitcnt lgkmcnt(3)
    v_mfma_f32_32x32x16_bf16 v[32:47], v[88:91], v[8:11], v[16:31]
    v_exp_f32 v48, v48
    v_exp_f32 v49, v49
    v_exp_f32 v50, v50
    v_exp_f32 v51, v51
    v_exp_f32 v52, v52
    v_exp_f32 v53, v53
    v_exp_f32 v54, v54
    v_exp_f32 v55, v55
    v_cvt_pk_bf16_f32 v80, v48, v49
    v_cvt_pk_bf16_f32 v81, v50, v51
    v_cvt_pk_bf16_f32 v82, v52, v53
    v_cvt_pk_bf16_f32 v83, v54, v55
    s_nop 1
    v_mfma_f32_32x32x16_bf16 v[64:79], v[108:111], v[80:83], v[64:79]
    v_exp_f32 v56, v56
    v_exp_f32 v57, v57
    v_exp_f32 v58, v58
    v_exp_f32 v59, v59
    v_exp_f32 v60, v60
    v_exp_f32 v61, v61
    v_exp_f32 v62, v62
    v_exp_f32 v63, v63
    v_cvt_pk_bf16_f32 v84, v56, v57
    v_cvt_pk_bf16_f32 v85, v58, v59
    v_cvt_pk_bf16_f32 v86, v60, v61
    v_cvt_pk_bf16_f32 v87, v62, v63
    s_nop 1
    v_mfma_f32_32x32x16_bf16 v[64:79], v[112:115], v[84:87], v[64:79]
    ds_read_b128 v[96:99], v6 offset:51200
    s_mov_b64 exec, s[24:25]
    ds_read_b128 v[108:111], v7 offset:50176
    ds_read_b128 v[112:115], v7 offset:50688
    s_mov_b64 exec, -1
    s_waitcnt lgkmcnt(3)
    v_mfma_f32_32x32x16_bf16 v[48:63], v[92:95], v[8:11], v[16:31]
    v_exp_f32 v32, v32
    v_exp_f32 v33, v33
    v_exp_f32 v34, v34
    v_exp_f32 v35, v35
    v_exp_f32 v36, v36
    v_exp_f32 v37, v37
    v_exp_f32 v38, v38
    v_exp_f32 v39, v39
    v_cvt_pk_bf16_f32 v80, v32, v33
    v_cvt_pk_bf16_f32 v81, v34, v35
    v_cvt_pk_bf16_f32 v82, v36, v37
    v_cvt_pk_bf16_f32 v83, v38, v39
    s_nop 1
    v_mfma_f32_32x32x16_bf16 v[64:79], v[100:103], v[80:83], v[64:79]
    v_exp_f32 v40, v40
    v_exp_f32 v41, v41
    v_exp_f32 v42, v42
    v_exp_f32 v43, v43
    v_exp_f32 v44, v44
    v_exp_f32 v45, v45
    v_exp_f32 v46, v46
    v_exp_f32 v47, v47
    v_cvt_pk_bf16_f32 v84, v40, v41
    v_cvt_pk_bf16_f32 v85, v42, v43
    v_cvt_pk_bf16_f32 v86, v44, v45
    v_cvt_pk_bf16_f32 v87, v46, v47
    s_nop 1
    v_mfma_f32_32x32x16_bf16 v[64:79], v[104:107], v[84:87], v[64:79]
    ds_read_b128 v[88:91], v6 offset:52224
    s_mov_b64 exec, s[24:25]
    ds_read_b128 v[100:103], v7 offset:51200
    ds_read_b128 v[104:107], v7 offset:51712
    s_mov_b64 exec, -1
    s_waitcnt lgkmcnt(3)
    v_mfma_f32_32x32x16_bf16 v[32:47], v[96:99], v[8:11], v[16:31]
    v_exp_f32 v48, v48
    v_exp_f32 v49, v49
    v_exp_f32 v50, v50
    v_exp_f32 v51, v51
    v_exp_f32 v52, v52
    v_exp_f32 v53, v53
    v_exp_f32 v54, v54
    v_exp_f32 v55, v55
    v_cvt_pk_bf16_f32 v80, v48, v49
    v_cvt_pk_bf16_f32 v81, v50, v51
    v_cvt_pk_bf16_f32 v82, v52, v53
    v_cvt_pk_bf16_f32 v83, v54, v55
    s_nop 1
    v_mfma_f32_32x32x16_bf16 v[64:79], v[108:111], v[80:83], v[64:79]
    v_exp_f32 v56, v56
    v_exp_f32 v57, v57
    v_exp_f32 v58, v58
    v_exp_f32 v59, v59
    v_exp_f32 v60, v60
    v_exp_f32 v61, v61
    v_exp_f32 v62, v62
    v_exp_f32 v63, v63
    v_cvt_pk_bf16_f32 v84, v56, v57
    v_cvt_pk_bf16_f32 v85, v58, v59
    v_cvt_pk_bf16_f32 v86, v60, v61
    v_cvt_pk_bf16_f32 v87, v62, v63
    s_nop 1
    v_mfma_f32_32x32x16_bf16 v[64:79], v[112:115], v[84:87], v[64:79]
    ds_read_b128 v[92:95], v6 offset:53248
    s_mov_b64 exec, s[24:25]
    ds_read_b128 v[108:111], v7 offset:52224
    ds_read_b128 v[112:115], v7 offset:52736
    s_mov_b64 exec, -1
    s_waitcnt lgkmcnt(3)
    v_mfma_f32_32x32x16_bf16 v[48:63], v[88:91], v[8:11], v[16:31]
    v_exp_f32 v32, v32
    v_exp_f32 v33, v33
    v_exp_f32 v34, v34
    v_exp_f32 v35, v35
    v_exp_f32 v36, v36
    v_exp_f32 v37, v37
    v_exp_f32 v38, v38
    v_exp_f32 v39, v39
    v_cvt_pk_bf16_f32 v80, v32, v33
    v_cvt_pk_bf16_f32 v81, v34, v35
    v_cvt_pk_bf16_f32 v82, v36, v37
    v_cvt_pk_bf16_f32 v83, v38, v39
    s_nop 1
    v_mfma_f32_32x32x16_bf16 v[64:79], v[100:103], v[80:83], v[64:79]
    v_exp_f32 v40, v40
    v_exp_f32 v41, v41
    v_exp_f32 v42, v42
    v_exp_f32 v43, v43
    v_exp_f32 v44, v44
    v_exp_f32 v45, v45
    v_exp_f32 v46, v46
    v_exp_f32 v47, v47
    v_cvt_pk_bf16_f32 v84, v40, v41
    v_cvt_pk_bf16_f32 v85, v42, v43
    v_cvt_pk_bf16_f32 v86, v44, v45
    v_cvt_pk_bf16_f32 v87, v46, v47
    s_nop 1
    v_mfma_f32_32x32x16_bf16 v[64:79], v[104:107], v[84:87], v[64:79]
    ds_read_b128 v[96:99], v6 offset:54272
    s_mov_b64 exec, s[24:25]
    ds_read_b128 v[100:103], v7 offset:53248
    ds_read_b128 v[104:107], v7 offset:53760
    s_mov_b64 exec, -1
    s_waitcnt lgkmcnt(3)
    v_mfma_f32_32x32x16_bf16 v[32:47], v[92:95], v[8:11], v[16:31]
    v_exp_f32 v48, v48
    v_exp_f32 v49, v49
    v_exp_f32 v50, v50
    v_exp_f32 v51, v51
    v_exp_f32 v52, v52
    v_exp_f32 v53, v53
    v_exp_f32 v54, v54
    v_exp_f32 v55, v55
    v_cvt_pk_bf16_f32 v80, v48, v49
    v_cvt_pk_bf16_f32 v81, v50, v51
    v_cvt_pk_bf16_f32 v82, v52, v53
    v_cvt_pk_bf16_f32 v83, v54, v55
    s_nop 1
    v_mfma_f32_32x32x16_bf16 v[64:79], v[108:111], v[80:83], v[64:79]
    v_exp_f32 v56, v56
    v_exp_f32 v57, v57
    v_exp_f32 v58, v58
    v_exp_f32 v59, v59
    v_exp_f32 v60, v60
    v_exp_f32 v61, v61
    v_exp_f32 v62, v62
    v_exp_f32 v63, v63
    v_cvt_pk_bf16_f32 v84, v56, v57
    v_cvt_pk_bf16_f32 v85, v58, v59
    v_cvt_pk_bf16_f32 v86, v60, v61
    v_cvt_pk_bf16_f32 v87, v62, v63
    s_nop 1
    v_mfma_f32_32x32x16_bf16 v[64:79], v[112:115], v[84:87], v[64:79]
    ds_read_b128 v[88:91], v6 offset:55296
    s_mov_b64 exec, s[24:25]
    ds_read_b128 v[108:111], v7 offset:54272
    ds_read_b128 v[112:115], v7 offset:54784
    s_mov_b64 exec, -1
    s_waitcnt lgkmcnt(3)
    v_mfma_f32_32x32x16_bf16 v[48:63], v[96:99], v[8:11], v[16:31]
    v_exp_f32 v32, v32
    v_exp_f32 v33, v33
    v_exp_f32 v34, v34
    v_exp_f32 v35, v35
    v_exp_f32 v36, v36
    v_exp_f32 v37, v37
    v_exp_f32 v38, v38
    v_exp_f32 v39, v39
    v_cvt_pk_bf16_f32 v80, v32, v33
    v_cvt_pk_bf16_f32 v81, v34, v35
    v_cvt_pk_bf16_f32 v82, v36, v37
    v_cvt_pk_bf16_f32 v83, v38, v39
    s_nop 1
    v_mfma_f32_32x32x16_bf16 v[64:79], v[100:103], v[80:83], v[64:79]
    v_exp_f32 v40, v40
    v_exp_f32 v41, v41
    v_exp_f32 v42, v42
    v_exp_f32 v43, v43
    v_exp_f32 v44, v44
    v_exp_f32 v45, v45
    v_exp_f32 v46, v46
    v_exp_f32 v47, v47
    v_cvt_pk_bf16_f32 v84, v40, v41
    v_cvt_pk_bf16_f32 v85, v42, v43
    v_cvt_pk_bf16_f32 v86, v44, v45
    v_cvt_pk_bf16_f32 v87, v46, v47
    s_nop 1
    v_mfma_f32_32x32x16_bf16 v[64:79], v[104:107], v[84:87], v[64:79]
    ds_read_b128 v[92:95], v6 offset:56320
    s_mov_b64 exec, s[24:25]
    ds_read_b128 v[100:103], v7 offset:55296
    ds_read_b128 v[104:107], v7 offset:55808
    s_mov_b64 exec, -1
    s_waitcnt lgkmcnt(3)
    v_mfma_f32_32x32x16_bf16 v[32:47], v[88:91], v[8:11], v[16:31]
    v_exp_f32 v48, v48
    v_exp_f32 v49, v49
    v_exp_f32 v50, v50
    v_exp_f32 v51, v51
    v_exp_f32 v52, v52
    v_exp_f32 v53, v53
    v_exp_f32 v54, v54
    v_exp_f32 v55, v55
    v_cvt_pk_bf16_f32 v80, v48, v49
    v_cvt_pk_bf16_f32 v81, v50, v51
    v_cvt_pk_bf16_f32 v82, v52, v53
    v_cvt_pk_bf16_f32 v83, v54, v55
    s_nop 1
    v_mfma_f32_32x32x16_bf16 v[64:79], v[108:111], v[80:83], v[64:79]
    v_exp_f32 v56, v56
    v_exp_f32 v57, v57
    v_exp_f32 v58, v58
    v_exp_f32 v59, v59
    v_exp_f32 v60, v60
    v_exp_f32 v61, v61
    v_exp_f32 v62, v62
    v_exp_f32 v63, v63
    v_cvt_pk_bf16_f32 v84, v56, v57
    v_cvt_pk_bf16_f32 v85, v58, v59
    v_cvt_pk_bf16_f32 v86, v60, v61
    v_cvt_pk_bf16_f32 v87, v62, v63
    s_nop 1
    v_mfma_f32_32x32x16_bf16 v[64:79], v[112:115], v[84:87], v[64:79]
    ds_read_b128 v[96:99], v6 offset:57344
    s_mov_b64 exec, s[24:25]
    ds_read_b128 v[108:111], v7 offset:56320
    ds_read_b128 v[112:115], v7 offset:56832
    s_mov_b64 exec, -1
    s_waitcnt lgkmcnt(3)
    v_mfma_f32_32x32x16_bf16 v[48:63], v[92:95], v[8:11], v[16:31]
    v_exp_f32 v32, v32
    v_exp_f32 v33, v33
    v_exp_f32 v34, v34
    v_exp_f32 v35, v35
    v_exp_f32 v36, v36
    v_exp_f32 v37, v37
    v_exp_f32 v38, v38
    v_exp_f32 v39, v39
    v_cvt_pk_bf16_f32 v80, v32, v33
    v_cvt_pk_bf16_f32 v81, v34, v35
    v_cvt_pk_bf16_f32 v82, v36, v37
    v_cvt_pk_bf16_f32 v83, v38, v39
    s_nop 1
    v_mfma_f32_32x32x16_bf16 v[64:79], v[100:103], v[80:83], v[64:79]
    v_exp_f32 v40, v40
    v_exp_f32 v41, v41
    v_exp_f32 v42, v42
    v_exp_f32 v43, v43
    v_exp_f32 v44, v44
    v_exp_f32 v45, v45
    v_exp_f32 v46, v46
    v_exp_f32 v47, v47
    v_cvt_pk_bf16_f32 v84, v40, v41
    v_cvt_pk_bf16_f32 v85, v42, v43
    v_cvt_pk_bf16_f32 v86, v44, v45
    v_cvt_pk_bf16_f32 v87, v46, v47
    s_nop 1
    v_mfma_f32_32x32x16_bf16 v[64:79], v[104:107], v[84:87], v[64:79]
    ds_read_b128 v[88:91], v6 offset:58368
    s_mov_b64 exec, s[24:25]
    ds_read_b128 v[100:103], v7 offset:57344
    ds_read_b128 v[104:107], v7 offset:57856
    s_mov_b64 exec, -1
    s_waitcnt lgkmcnt(3)
    v_mfma_f32_32x32x16_bf16 v[32:47], v[96:99], v[8:11], v[16:31]
    v_exp_f32 v48, v48
    v_exp_f32 v49, v49
    v_exp_f32 v50, v50
    v_exp_f32 v51, v51
    v_exp_f32 v52, v52
    v_exp_f32 v53, v53
    v_exp_f32 v54, v54
    v_exp_f32 v55, v55
    v_cvt_pk_bf16_f32 v80, v48, v49
    v_cvt_pk_bf16_f32 v81, v50, v51
    v_cvt_pk_bf16_f32 v82, v52, v53
    v_cvt_pk_bf16_f32 v83, v54, v55
    s_nop 1
    v_mfma_f32_32x32x16_bf16 v[64:79], v[108:111], v[80:83], v[64:79]
    v_exp_f32 v56, v56
    v_exp_f32 v57, v57
    v_exp_f32 v58, v58
    v_exp_f32 v59, v59
    v_exp_f32 v60, v60
    v_exp_f32 v61, v61
    v_exp_f32 v62, v62
    v_exp_f32 v63, v63
    v_cvt_pk_bf16_f32 v84, v56, v57
    v_cvt_pk_bf16_f32 v85, v58, v59
    v_cvt_pk_bf16_f32 v86, v60, v61
    v_cvt_pk_bf16_f32 v87, v62, v63
    s_nop 1
    v_mfma_f32_32x32x16_bf16 v[64:79], v[112:115], v[84:87], v[64:79]
    ds_read_b128 v[92:95], v6 offset:59392
    s_mov_b64 exec, s[24:25]
    ds_read_b128 v[108:111], v7 offset:58368
    ds_read_b128 v[112:115], v7 offset:58880
    s_mov_b64 exec, -1
    s_waitcnt lgkmcnt(3)
    v_mfma_f32_32x32x16_bf16 v[48:63], v[88:91], v[8:11], v[16:31]
    v_exp_f32 v32, v32
    v_exp_f32 v33, v33
    v_exp_f32 v34, v34
    v_exp_f32 v35, v35
    v_exp_f32 v36, v36
    v_exp_f32 v37, v37
    v_exp_f32 v38, v38
    v_exp_f32 v39, v39
    v_cvt_pk_bf16_f32 v80, v32, v33
    v_cvt_pk_bf16_f32 v81, v34, v35
    v_cvt_pk_bf16_f32 v82, v36, v37
    v_cvt_pk_bf16_f32 v83, v38, v39
    s_nop 1
    v_mfma_f32_32x32x16_bf16 v[64:79], v[100:103], v[80:83], v[64:79]
    v_exp_f32 v40, v40
    v_exp_f32 v41, v41
    v_exp_f32 v42, v42
    v_exp_f32 v43, v43
    v_exp_f32 v44, v44
    v_exp_f32 v45, v45
    v_exp_f32 v46, v46
    v_exp_f32 v47, v47
    v_cvt_pk_bf16_f32 v84, v40, v41
    v_cvt_pk_bf16_f32 v85, v42, v43
    v_cvt_pk_bf16_f32 v86, v44, v45
    v_cvt_pk_bf16_f32 v87, v46, v47
    s_nop 1
    v_mfma_f32_32x32x16_bf16 v[64:79], v[104:107], v[84:87], v[64:79]
    ds_read_b128 v[96:99], v6 offset:60416
    s_mov_b64 exec, s[24:25]
    ds_read_b128 v[100:103], v7 offset:59392
    ds_read_b128 v[104:107], v7 offset:59904
    s_mov_b64 exec, -1
    s_waitcnt lgkmcnt(3)
    v_mfma_f32_32x32x16_bf16 v[32:47], v[92:95], v[8:11], v[16:31]
    v_exp_f32 v48, v48
    v_exp_f32 v49, v49
    v_exp_f32 v50, v50
    v_exp_f32 v51, v51
    v_exp_f32 v52, v52
    v_exp_f32 v53, v53
    v_exp_f32 v54, v54
    v_exp_f32 v55, v55
    v_cvt_pk_bf16_f32 v80, v48, v49
    v_cvt_pk_bf16_f32 v81, v50, v51
    v_cvt_pk_bf16_f32 v82, v52, v53
    v_cvt_pk_bf16_f32 v83, v54, v55
    s_nop 1
    v_mfma_f32_32x32x16_bf16 v[64:79], v[108:111], v[80:83], v[64:79]
    v_exp_f32 v56, v56
    v_exp_f32 v57, v57
    v_exp_f32 v58, v58
    v_exp_f32 v59, v59
    v_exp_f32 v60, v60
    v_exp_f32 v61, v61
    v_exp_f32 v62, v62
    v_exp_f32 v63, v63
    v_cvt_pk_bf16_f32 v84, v56, v57
    v_cvt_pk_bf16_f32 v85, v58, v59
    v_cvt_pk_bf16_f32 v86, v60, v61
    v_cvt_pk_bf16_f32 v87, v62, v63
    s_nop 1
    v_mfma_f32_32x32x16_bf16 v[64:79], v[112:115], v[84:87], v[64:79]
    ds_read_b128 v[88:91], v6 offset:61440
    s_mov_b64 exec, s[24:25]
    ds_read_b128 v[108:111], v7 offset:60416
    ds_read_b128 v[112:115], v7 offset:60928
    s_mov_b64 exec, -1
    s_waitcnt lgkmcnt(3)
    v_mfma_f32_32x32x16_bf16 v[48:63], v[96:99], v[8:11], v[16:31]
    v_exp_f32 v32, v32
    v_exp_f32 v33, v33
    v_exp_f32 v34, v34
    v_exp_f32 v35, v35
    v_exp_f32 v36, v36
    v_exp_f32 v37, v37
    v_exp_f32 v38, v38
    v_exp_f32 v39, v39
    v_cvt_pk_bf16_f32 v80, v32, v33
    v_cvt_pk_bf16_f32 v81, v34, v35
    v_cvt_pk_bf16_f32 v82, v36, v37
    v_cvt_pk_bf16_f32 v83, v38, v39
    s_nop 1
    v_mfma_f32_32x32x16_bf16 v[64:79], v[100:103], v[80:83], v[64:79]
    v_exp_f32 v40, v40
    v_exp_f32 v41, v41
    v_exp_f32 v42, v42
    v_exp_f32 v43, v43
    v_exp_f32 v44, v44
    v_exp_f32 v45, v45
    v_exp_f32 v46, v46
    v_exp_f32 v47, v47
    v_cvt_pk_bf16_f32 v84, v40, v41
    v_cvt_pk_bf16_f32 v85, v42, v43
    v_cvt_pk_bf16_f32 v86, v44, v45
    v_cvt_pk_bf16_f32 v87, v46, v47
    s_nop 1
    v_mfma_f32_32x32x16_bf16 v[64:79], v[104:107], v[84:87], v[64:79]
    ds_read_b128 v[92:95], v6 offset:62464
    s_mov_b64 exec, s[24:25]
    ds_read_b128 v[100:103], v7 offset:61440
    ds_read_b128 v[104:107], v7 offset:61952
    s_mov_b64 exec, -1
    s_waitcnt lgkmcnt(3)
    v_mfma_f32_32x32x16_bf16 v[32:47], v[88:91], v[8:11], v[16:31]
    v_exp_f32 v48, v48
    v_exp_f32 v49, v49
    v_exp_f32 v50, v50
    v_exp_f32 v51, v51
    v_exp_f32 v52, v52
    v_exp_f32 v53, v53
    v_exp_f32 v54, v54
    v_exp_f32 v55, v55
    v_cvt_pk_bf16_f32 v80, v48, v49
    v_cvt_pk_bf16_f32 v81, v50, v51
    v_cvt_pk_bf16_f32 v82, v52, v53
    v_cvt_pk_bf16_f32 v83, v54, v55
    s_nop 1
    v_mfma_f32_32x32x16_bf16 v[64:79], v[108:111], v[80:83], v[64:79]
    v_exp_f32 v56, v56
    v_exp_f32 v57, v57
    v_exp_f32 v58, v58
    v_exp_f32 v59, v59
    v_exp_f32 v60, v60
    v_exp_f32 v61, v61
    v_exp_f32 v62, v62
    v_exp_f32 v63, v63
    v_cvt_pk_bf16_f32 v84, v56, v57
    v_cvt_pk_bf16_f32 v85, v58, v59
    v_cvt_pk_bf16_f32 v86, v60, v61
    v_cvt_pk_bf16_f32 v87, v62, v63
    s_nop 1
    v_mfma_f32_32x32x16_bf16 v[64:79], v[112:115], v[84:87], v[64:79]
    ds_read_b128 v[96:99], v6 offset:63488
    s_mov_b64 exec, s[24:25]
    ds_read_b128 v[108:111], v7 offset:62464
    ds_read_b128 v[112:115], v7 offset:62976
    s_mov_b64 exec, -1
    s_waitcnt lgkmcnt(3)
    v_mfma_f32_32x32x16_bf16 v[48:63], v[92:95], v[8:11], v[16:31]
    v_exp_f32 v32, v32
    v_exp_f32 v33, v33
    v_exp_f32 v34, v34
    v_exp_f32 v35, v35
    v_exp_f32 v36, v36
    v_exp_f32 v37, v37
    v_exp_f32 v38, v38
    v_exp_f32 v39, v39
    v_cvt_pk_bf16_f32 v80, v32, v33
    v_cvt_pk_bf16_f32 v81, v34, v35
    v_cvt_pk_bf16_f32 v82, v36, v37
    v_cvt_pk_bf16_f32 v83, v38, v39
    s_nop 1
    v_mfma_f32_32x32x16_bf16 v[64:79], v[100:103], v[80:83], v[64:79]
    v_exp_f32 v40, v40
    v_exp_f32 v41, v41
    v_exp_f32 v42, v42
    v_exp_f32 v43, v43
    v_exp_f32 v44, v44
    v_exp_f32 v45, v45
    v_exp_f32 v46, v46
    v_exp_f32 v47, v47
    v_cvt_pk_bf16_f32 v84, v40, v41
    v_cvt_pk_bf16_f32 v85, v42, v43
    v_cvt_pk_bf16_f32 v86, v44, v45
    v_cvt_pk_bf16_f32 v87, v46, v47
    s_nop 1
    v_mfma_f32_32x32x16_bf16 v[64:79], v[104:107], v[84:87], v[64:79]
    ds_read_b128 v[88:91], v6 offset:64512
    s_mov_b64 exec, s[24:25]
    ds_read_b128 v[100:103], v7 offset:63488
    ds_read_b128 v[104:107], v7 offset:64000
    s_mov_b64 exec, -1
    s_waitcnt lgkmcnt(3)
    v_mfma_f32_32x32x16_bf16 v[32:47], v[96:99], v[8:11], v[16:31]
    v_exp_f32 v48, v48
    v_exp_f32 v49, v49
    v_exp_f32 v50, v50
    v_exp_f32 v51, v51
    v_exp_f32 v52, v52
    v_exp_f32 v53, v53
    v_exp_f32 v54, v54
    v_exp_f32 v55, v55
    v_cvt_pk_bf16_f32 v80, v48, v49
    v_cvt_pk_bf16_f32 v81, v50, v51
    v_cvt_pk_bf16_f32 v82, v52, v53
    v_cvt_pk_bf16_f32 v83, v54, v55
    s_nop 1
    v_mfma_f32_32x32x16_bf16 v[64:79], v[108:111], v[80:83], v[64:79]
    v_exp_f32 v56, v56
    v_exp_f32 v57, v57
    v_exp_f32 v58, v58
    v_exp_f32 v59, v59
    v_exp_f32 v60, v60
    v_exp_f32 v61, v61
    v_exp_f32 v62, v62
    v_exp_f32 v63, v63
    v_cvt_pk_bf16_f32 v84, v56, v57
    v_cvt_pk_bf16_f32 v85, v58, v59
    v_cvt_pk_bf16_f32 v86, v60, v61
    v_cvt_pk_bf16_f32 v87, v62, v63
    s_nop 1
    v_mfma_f32_32x32x16_bf16 v[64:79], v[112:115], v[84:87], v[64:79]
    s_mov_b64 exec, s[24:25]
    ds_read_b128 v[108:111], v7 offset:64512
    ds_read_b128 v[112:115], v7 offset:65024
    s_mov_b64 exec, -1
    s_waitcnt lgkmcnt(2)
    v_mfma_f32_32x32x16_bf16 v[48:63], v[88:91], v[8:11], v[16:31]
    v_exp_f32 v32, v32
    v_exp_f32 v33, v33
    v_exp_f32 v34, v34
    v_exp_f32 v35, v35
    v_exp_f32 v36, v36
    v_exp_f32 v37, v37
    v_exp_f32 v38, v38
    v_exp_f32 v39, v39
    v_cvt_pk_bf16_f32 v80, v32, v33
    v_cvt_pk_bf16_f32 v81, v34, v35
    v_cvt_pk_bf16_f32 v82, v36, v37
    v_cvt_pk_bf16_f32 v83, v38, v39
    s_nop 1
    v_mfma_f32_32x32x16_bf16 v[64:79], v[100:103], v[80:83], v[64:79]
    v_exp_f32 v40, v40
    v_exp_f32 v41, v41
    v_exp_f32 v42, v42
    v_exp_f32 v43, v43
    v_exp_f32 v44, v44
    v_exp_f32 v45, v45
    v_exp_f32 v46, v46
    v_exp_f32 v47, v47
    v_cvt_pk_bf16_f32 v84, v40, v41
    v_cvt_pk_bf16_f32 v85, v42, v43
    v_cvt_pk_bf16_f32 v86, v44, v45
    v_cvt_pk_bf16_f32 v87, v46, v47
    s_nop 1
    v_mfma_f32_32x32x16_bf16 v[64:79], v[104:107], v[84:87], v[64:79]
    s_waitcnt lgkmcnt(0)
    v_exp_f32 v48, v48
    v_exp_f32 v49, v49
    v_exp_f32 v50, v50
    v_exp_f32 v51, v51
    v_exp_f32 v52, v52
    v_exp_f32 v53, v53
    v_exp_f32 v54, v54
    v_exp_f32 v55, v55
    v_cvt_pk_bf16_f32 v80, v48, v49
    v_cvt_pk_bf16_f32 v81, v50, v51
    v_cvt_pk_bf16_f32 v82, v52, v53
    v_cvt_pk_bf16_f32 v83, v54, v55
    s_nop 1
    v_mfma_f32_32x32x16_bf16 v[64:79], v[108:111], v[80:83], v[64:79]
    v_exp_f32 v56, v56
    v_exp_f32 v57, v57
    v_exp_f32 v58, v58
    v_exp_f32 v59, v59
    v_exp_f32 v60, v60
    v_exp_f32 v61, v61
    v_exp_f32 v62, v62
    v_exp_f32 v63, v63
    v_cvt_pk_bf16_f32 v84, v56, v57
    v_cvt_pk_bf16_f32 v85, v58, v59
    v_cvt_pk_bf16_f32 v86, v60, v61
    v_cvt_pk_bf16_f32 v87, v62, v63
    s_nop 1
    v_mfma_f32_32x32x16_bf16 v[64:79], v[112:115], v[84:87], v[64:79]
    s_nop 15
    s_cmp_eq_u32 s26, 1
    s_cbranch_scc1 K2_EPI
    v_cmp_ngt_f32 vcc, 0x5d800000, v72
    s_nop 4
    s_cmp_eq_u64 vcc, 0
    s_cbranch_scc1 K2_EPI
    v_mov_b32 v12, 0xff800000
    s_mov_b32 s47, 0
    v_mov_b32 v2, v6
K2_P1LOOP:
    ds_read_b128 v[88:91], v2
    s_waitcnt lgkmcnt(0)
    v_mfma_f32_32x32x16_bf16 v[32:47], v[88:91], v[8:11], 0
    s_nop 15
    v_max3_f32 v12, v12, v32, v33
    v_max3_f32 v12, v12, v34, v35
    v_max3_f32 v12, v12, v36, v37
    v_max3_f32 v12, v12, v38, v39
    v_max3_f32 v12, v12, v40, v41
    v_max3_f32 v12, v12, v42, v43
    v_max3_f32 v12, v12, v44, v45
    v_max3_f32 v12, v12, v46, v47
    v_add_u32 v2, 1024, v2
    s_add_u32 s47, s47, 1
    s_cmp_lt_u32 s47, 64
    s_cbranch_scc1 K2_P1LOOP
    v_mov_b32 v3, v12
    s_nop 1
    v_permlane32_swap_b32 v12, v3
    v_max_f32 v12, v12, v3
    v_sub_f32 v12, 0, v12
    v_mov_b32 v16, v12
    v_mov_b32 v17, v12
    v_mov_b32 v18, v12
    v_mov_b32 v19, v12
    v_mov_b32 v20, v12
    v_mov_b32 v21, v12
    v_mov_b32 v22, v12
    v_mov_b32 v23, v12
    v_mov_b32 v24, v12
    v_mov_b32 v25, v12
    v_mov_b32 v26, v12
    v_mov_b32 v27, v12
    v_mov_b32 v28, v12
    v_mov_b32 v29, v12
    v_mov_b32 v30, v12
    v_mov_b32 v31, v12
    s_mov_b32 s26, 1
    s_branch K2_PASS2
K2_EPI:
    v_rcp_f32 v2, v72
    s_nop 0
    v_mul_f32 v64, v64, v2
    v_mul_f32 v65, v65, v2
    v_mul_f32 v66, v66, v2
    v_mul_f32 v67, v67, v2
    v_mul_f32 v68, v68, v2
    v_mul_f32 v69, v69, v2
    v_mul_f32 v70, v70, v2
    v_mul_f32 v71, v71, v2
    v_cvt_pk_bf16_f32 v80, v64, v65
    v_cvt_pk_bf16_f32 v81, v66, v67
    v_cvt_pk_bf16_f32 v82, v68, v69
    v_cvt_pk_bf16_f32 v83, v70, v71
    s_lshl_b32 s47, s21, 3
    s_add_u32 s47, s47, s22
    s_lshl_b32 s47, s47, 5
    s_add_u32 s47, s47, s20
    s_lshl_b32 s47, s47, 10
    s_add_u32 s47, s47, 12582912
    buffer_store_dwordx4 v[80:83], v5, s[16:19], s47 offen
    s_endpgm
.section .rodata,"a"
.p2align 6
.amdhsa_kernel attn_kernel
  .amdhsa_next_free_vgpr 128
  .amdhsa_next_free_sgpr 102
  .amdhsa_accum_offset 128
  .amdhsa_group_segment_fixed_size 0
  .amdhsa_kernarg_size 88
  .amdhsa_user_sgpr_count 2
  .amdhsa_user_sgpr_kernarg_segment_ptr 1
  .amdhsa_system_sgpr_workgroup_id_x 1
.end_amdhsa_kernel
.text
.globl out_kernel
.p2align 8
.type out_kernel,@function
out_kernel:
    s_cmp_ge_u32 s2, 256
    s_cbranch_scc1 K3_END
    s_load_dwordx2 s[12:13], s[0:1], 64
    s_load_dwordx2 s[14:15], s[0:1], 80
    s_and_b32 s44, s2, 7
    s_lshr_b32 s45, s2, 3
    s_lshl_b32 s44, s44, 2
    s_and_b32 s46, s45, 3
    s_add_u32 s40, s44, s46
    s_lshr_b32 s41, s45, 2
    v_and_b32 v1, 63, v0
    v_lshrrev_b32 v2, 6, v0
    v_lshlrev_b32 v4, 4, v1
    v_readfirstlane_b32 s42, v2
    s_waitcnt lgkmcnt(0)
    s_mov_b32 s16, s14
    s_and_b32 s17, s15, 0xffff
    s_mov_b32 s18, 268435456
    s_mov_b32 s19, 0x00020000
    s_mov_b32 s36, s12
    s_and_b32 s37, s13, 0xffff
    s_mov_b32 s38, 2097152
    s_mov_b32 s39, 0x00020000
    s_lshr_b32 s43, s42, 1
    s_and_b32 s49, s42, 1
    s_lshl_b32 s44, s40, 6
    s_lshl_b32 s45, s42, 3
    s_add_u32 s44, s44, s45
    s_lshl_b32 s44, s44, 10
    s_add_u32 s44, s44, 12582912
    s_lshl_b32 s45, s42, 7
    s_lshl_b32 s46, s41, 1
    s_add_u32 s45, s45, s46
    s_lshl_b32 s45, s45, 10
    s_add_u32 s45, s45, 23068672
    s_add_u32 s46, s44, 0
    buffer_load_dwordx4 v[96:99], v4, s[16:19], s46 offen
    s_add_u32 s46, s44, 32768
    buffer_load_dwordx4 v[100:103], v4, s[16:19], s46 offen
    s_add_u32 s46, s45, 0
    buffer_load_dwordx4 v[104:107], v4, s[16:19], s46 offen
    buffer_load_dwordx4 v[108:111], v4, s[16:19], s46 offen offset:1024
    s_add_u32 s46, s44, 1024
    buffer_load_dwordx4 v[112:115], v4, s[16:19], s46 offen
    s_add_u32 s46, s44, 33792
    buffer_load_dwordx4 v[116:119], v4, s[16:19], s46 offen
    s_add_u32 s46, s45, 16384
    buffer_load_dwordx4 v[120:123], v4, s[16:19], s46 offen
    buffer_load_dwordx4 v[124:127], v4, s[16:19], s46 offen offset:1024
    s_add_u32 s46, s44, 2048
    buffer_load_dwordx4 v[128:131], v4, s[16:19], s46 offen
    s_add_u32 s46, s44, 34816
    buffer_load_dwordx4 v[132:135], v4, s[16:19], s46 offen
    s_add_u32 s46, s45, 32768
    buffer_load_dwordx4 v[136:139], v4, s[16:19], s46 offen
    buffer_load_dwordx4 v[140:143], v4, s[16:19], s46 offen offset:1024
    s_add_u32 s46, s44, 3072
    buffer_load_dwordx4 v[144:147], v4, s[16:19], s46 offen
    s_add_u32 s46, s44, 35840
    buffer_load_dwordx4 v[148:151], v4, s[16:19], s46 offen
    s_add_u32 s46, s45, 49152
    buffer_load_dwordx4 v[152:155], v4, s[16:19], s46 offen
    buffer_load_dwordx4 v[156:159], v4, s[16:19], s46 offen offset:1024
    s_add_u32 s46, s44, 4096
    buffer_load_dwordx4 v[160:163], v4, s[16:19], s46 offen
    s_add_u32 s46, s44, 36864
    buffer_load_dwordx4 v[164:167], v4, s[16:19], s46 offen
    s_add_u32 s46, s45, 65536
    buffer_load_dwordx4 v[168:171], v4, s[16:19], s46 offen
    buffer_load_dwordx4 v[172:175], v4, s[16:19], s46 offen offset:1024
    s_add_u32 s46, s44, 5120
    buffer_load_dwordx4 v[176:179], v4, s[16:19], s46 offen
    s_add_u32 s46, s44, 37888
    buffer_load_dwordx4 v[180:183], v4, s[16:19], s46 offen
    s_add_u32 s46, s45, 81920
    buffer_load_dwordx4 v[184:187], v4, s[16:19], s46 offen
    buffer_load_dwordx4 v[188:191], v4, s[16:19], s46 offen offset:1024
    s_add_u32 s46, s44, 6144
    buffer_load_dwordx4 v[192:195], v4, s[16:19], s46 offen
    s_add_u32 s46, s44, 38912
    buffer_load_dwordx4 v[196:199], v4, s[16:19], s46 offen
    s_add_u32 s46, s45, 98304
    buffer_load_dwordx4 v[200:203], v4, s[16:19], s46 offen
    buffer_load_dwordx4 v[204:207], v4, s[16:19], s46 offen offset:1024
    s_add_u32 s46, s44, 7168
    buffer_load_dwordx4 v[208:211], v4, s[16:19], s46 offen
    s_add_u32 s46, s44, 39936
    buffer_load_dwordx4 v[212:215], v4, s[16:19], s46 offen
    s_add_u32 s46, s45, 114688
    buffer_load_dwordx4 v[216:219], v4, s[16:19], s46 offen
    buffer_load_dwordx4 v[220:223], v4, s[16:19], s46 offen offset:1024
    v_and_b32 v2, 31, v1
    s_lshl_b32 s44, s40, 6
    s_lshl_b32 s45, s43, 5
    s_add_u32 s44, s44, s45
    v_add_u32 v5, s44, v2
    v_lshlrev_b32 v2, 2, v5
    s_mov_b32 s44, 14680064
    buffer_load_dword v6, v2, s[16:19], s44 offen
    s_lshl_b32 s47, s40, 1
    s_add_u32 s47, s47, s43
    s_lshl_b32 s47, s47, 4
    s_lshl_b32 s48, s41, 1
    s_add_u32 s47, s47, s48
    s_add_u32 s47, s47, s49
    s_lshl_b32 s47, s47, 11
    s_add_u32 s47, s47, 16777216
    buffer_load_dwordx4 v[16:19], v4, s[16:19], s47 offen offset:0
    buffer_load_dwordx4 v[20:23], v4, s[16:19], s47 offen offset:1024
    s_waitcnt vmcnt(31)
    v_mfma_f32_32x32x16_bf16 v[32:47], v[104:107], v[96:99], 0
    v_mfma_f32_32x32x16_bf16 v[48:63], v[108:111], v[96:99], 0
    v_mfma_f32_32x32x16_bf16 v[64:79], v[104:107], v[100:103], 0
    v_mfma_f32_32x32x16_bf16 v[80:95], v[108:111], v[100:103], 0
    s_waitcnt vmcnt(27)
    v_mfma_f32_32x32x16_bf16 v[32:47], v[120:123], v[112:115], v[32:47]
    v_mfma_f32_32x32x16_bf16 v[48:63], v[124:127], v[112:115], v[48:63]
    v_mfma_f32_32x32x16_bf16 v[64:79], v[120:123], v[116:119], v[64:79]
    v_mfma_f32_32x32x16_bf16 v[80:95], v[124:127], v[116:119], v[80:95]
    s_waitcnt vmcnt(23)
    v_mfma_f32_32x32x16_bf16 v[32:47], v[136:139], v[128:131], v[32:47]
    v_mfma_f32_32x32x16_bf16 v[48:63], v[140:143], v[128:131], v[48:63]
    v_mfma_f32_32x32x16_bf16 v[64:79], v[136:139], v[132:135], v[64:79]
    v_mfma_f32_32x32x16_bf16 v[80:95], v[140:143], v[132:135], v[80:95]
    s_waitcnt vmcnt(19)
    v_mfma_f32_32x32x16_bf16 v[32:47], v[152:155], v[144:147], v[32:47]
    v_mfma_f32_32x32x16_bf16 v[48:63], v[156:159], v[144:147], v[48:63]
    v_mfma_f32_32x32x16_bf16 v[64:79], v[152:155], v[148:151], v[64:79]
    v_mfma_f32_32x32x16_bf16 v[80:95], v[156:159], v[148:151], v[80:95]
    s_waitcnt vmcnt(15)
    v_mfma_f32_32x32x16_bf16 v[32:47], v[168:171], v[160:163], v[32:47]
    v_mfma_f32_32x32x16_bf16 v[48:63], v[172:175], v[160:163], v[48:63]
    v_mfma_f32_32x32x16_bf16 v[64:79], v[168:171], v[164:167], v[64:79]
    v_mfma_f32_32x32x16_bf16 v[80:95], v[172:175], v[164:167], v[80:95]
    s_waitcnt vmcnt(11)
    v_mfma_f32_32x32x16_bf16 v[32:47], v[184:187], v[176:179], v[32:47]
    v_mfma_f32_32x32x16_bf16 v[48:63], v[188:191], v[176:179], v[48:63]
    v_mfma_f32_32x32x16_bf16 v[64:79], v[184:187], v[180:183], v[64:79]
    v_mfma_f32_32x32x16_bf16 v[80:95], v[188:191], v[180:183], v[80:95]
    s_waitcnt vmcnt(7)
    v_mfma_f32_32x32x16_bf16 v[32:47], v[200:203], v[192:195], v[32:47]
    v_mfma_f32_32x32x16_bf16 v[48:63], v[204:207], v[192:195], v[48:63]
    v_mfma_f32_32x32x16_bf16 v[64:79], v[200:203], v[196:199], v[64:79]
    v_mfma_f32_32x32x16_bf16 v[80:95], v[204:207], v[196:199], v[80:95]
    s_waitcnt vmcnt(3)
    v_mfma_f32_32x32x16_bf16 v[32:47], v[216:219], v[208:211], v[32:47]
    v_mfma_f32_32x32x16_bf16 v[48:63], v[220:223], v[208:211], v[48:63]
    v_mfma_f32_32x32x16_bf16 v[64:79], v[216:219], v[212:215], v[64:79]
    v_mfma_f32_32x32x16_bf16 v[80:95], v[220:223], v[212:215], v[80:95]
    s_lshl_b32 s44, s42, 12
    v_add_u32 v2, s44, v4
    s_nop 15
    s_cmp_eq_u32 s42, 0
    s_cbranch_scc1 K3_SK0
    ds_write_b128 v2, v[32:35] offset:0
    ds_write_b128 v2, v[36:39] offset:1024
    ds_write_b128 v2, v[40:43] offset:2048
    ds_write_b128 v2, v[44:47] offset:3072
K3_SK0:
    s_cmp_eq_u32 s42, 1
    s_cbranch_scc1 K3_SK1
    ds_write_b128 v2, v[48:51] offset:16384
    ds_write_b128 v2, v[52:55] offset:17408
    ds_write_b128 v2, v[56:59] offset:18432
    ds_write_b128 v2, v[60:63] offset:19456
K3_SK1:
    s_cmp_eq_u32 s42, 2
    s_cbranch_scc1 K3_SK2
    ds_write_b128 v2, v[64:67] offset:32768
    ds_write_b128 v2, v[68:71] offset:33792
    ds_write_b128 v2, v[72:75] offset:34816
    ds_write_b128 v2, v[76:79] offset:35840
K3_SK2:
    s_cmp_eq_u32 s42, 3
    s_cbranch_scc1 K3_SK3
    ds_write_b128 v2, v[80:83] offset:49152
    ds_write_b128 v2, v[84:87] offset:50176
    ds_write_b128 v2, v[88:91] offset:51200
    ds_write_b128 v2, v[92:95] offset:52224
K3_SK3:
    s_cmp_lg_u32 s42, 0
    s_cbranch_scc1 K3_MV0
    v_mov_b32 v96, v32
    v_mov_b32 v97, v33
    v_mov_b32 v98, v34
    v_mov_b32 v99, v35
    v_mov_b32 v100, v36
    v_mov_b32 v101, v37
    v_mov_b32 v102, v38
    v_mov_b32 v103, v39
    v_mov_b32 v104, v40
    v_mov_b32 v105, v41
    v_mov_b32 v106, v42
    v_mov_b32 v107, v43
    v_mov_b32 v108, v44
    v_mov_b32 v109, v45
    v_mov_b32 v110, v46
    v_mov_b32 v111, v47
K3_MV0:
    s_cmp_lg_u32 s42, 1
    s_cbranch_scc1 K3_MV1
    v_mov_b32 v96, v48
    v_mov_b32 v97, v49
    v_mov_b32 v98, v50
    v_mov_b32 v99, v51
    v_mov_b32 v100, v52
    v_mov_b32 v101, v53
    v_mov_b32 v102, v54
    v_mov_b32 v103, v55
    v_mov_b32 v104, v56
    v_mov_b32 v105, v57
    v_mov_b32 v106, v58
    v_mov_b32 v107, v59
    v_mov_b32 v108, v60
    v_mov_b32 v109, v61
    v_mov_b32 v110, v62
    v_mov_b32 v111, v63
K3_MV1:
    s_cmp_lg_u32 s42, 2
    s_cbranch_scc1 K3_MV2
    v_mov_b32 v96, v64
    v_mov_b32 v97, v65
    v_mov_b32 v98, v66
    v_mov_b32 v99, v67
    v_mov_b32 v100, v68
    v_mov_b32 v101, v69
    v_mov_b32 v102, v70
    v_mov_b32 v103, v71
    v_mov_b32 v104, v72
    v_mov_b32 v105, v73
    v_mov_b32 v106, v74
    v_mov_b32 v107, v75
    v_mov_b32 v108, v76
    v_mov_b32 v109, v77
    v_mov_b32 v110, v78
    v_mov_b32 v111, v79
K3_MV2:
    s_cmp_lg_u32 s42, 3
    s_cbranch_scc1 K3_MV3
    v_mov_b32 v96, v80
    v_mov_b32 v97, v81
    v_mov_b32 v98, v82
    v_mov_b32 v99, v83
    v_mov_b32 v100, v84
    v_mov_b32 v101, v85
    v_mov_b32 v102, v86
    v_mov_b32 v103, v87
    v_mov_b32 v104, v88
    v_mov_b32 v105, v89
    v_mov_b32 v106, v90
    v_mov_b32 v107, v91
    v_mov_b32 v108, v92
    v_mov_b32 v109, v93
    v_mov_b32 v110, v94
    v_mov_b32 v111, v95
K3_MV3:
    s_waitcnt lgkmcnt(0)
    s_barrier
    s_lshl_b32 s44, s42, 14
    v_add_u32 v2, s44, v4
    ds_read_b128 v[32:35], v2 offset:0
    ds_read_b128 v[36:39], v2 offset:1024
    ds_read_b128 v[40:43], v2 offset:2048
    ds_read_b128 v[44:47], v2 offset:3072
    ds_read_b128 v[48:51], v2 offset:4096
    ds_read_b128 v[52:55], v2 offset:5120
    ds_read_b128 v[56:59], v2 offset:6144
    ds_read_b128 v[60:63], v2 offset:7168
    ds_read_b128 v[64:67], v2 offset:8192
    ds_read_b128 v[68:71], v2 offset:9216
    ds_read_b128 v[72:75], v2 offset:10240
    ds_read_b128 v[76:79], v2 offset:11264
    ds_read_b128 v[80:83], v2 offset:12288
    ds_read_b128 v[84:87], v2 offset:13312
    ds_read_b128 v[88:91], v2 offset:14336
    ds_read_b128 v[92:95], v2 offset:15360
    s_waitcnt vmcnt(0)
    v_lshlrev_b32 v8, 16, v16
    v_and_b32 v9, 0xffff0000, v16
    v_lshlrev_b32 v10, 16, v17
    v_and_b32 v11, 0xffff0000, v17
    v_lshlrev_b32 v12, 16, v18
    v_and_b32 v13, 0xffff0000, v18
    v_lshlrev_b32 v14, 16, v19
    v_and_b32 v15, 0xffff0000, v19
    v_lshlrev_b32 v16, 16, v20
    v_and_b32 v17, 0xffff0000, v20
    v_lshlrev_b32 v18, 16, v21
    v_and_b32 v19, 0xffff0000, v21
    v_lshlrev_b32 v20, 16, v22
    v_and_b32 v21, 0xffff0000, v22
    v_lshlrev_b32 v22, 16, v23
    v_and_b32 v23, 0xffff0000, v23
    s_waitcnt lgkmcnt(0)
    s_cmp_eq_u32 s42, 0
    s_cbranch_scc1 K3_AD0
    v_add_f32 v96, v96, v32
    v_add_f32 v97, v97, v33
    v_add_f32 v98, v98, v34
    v_add_f32 v99, v99, v35
    v_add_f32 v100, v100, v36
    v_add_f32 v101, v101, v37
    v_add_f32 v102, v102, v38
    v_add_f32 v103, v103, v39
    v_add_f32 v104, v104, v40
    v_add_f32 v105, v105, v41
    v_add_f32 v106, v106, v42
    v_add_f32 v107, v107, v43
    v_add_f32 v108, v108, v44
    v_add_f32 v109, v109, v45
    v_add_f32 v110, v110, v46
    v_add_f32 v111, v111, v47
K3_AD0:
    s_cmp_eq_u32 s42, 1
    s_cbranch_scc1 K3_AD1
    v_add_f32 v96, v96, v48
    v_add_f32 v97, v97, v49
    v_add_f32 v98, v98, v50
    v_add_f32 v99, v99, v51
    v_add_f32 v100, v100, v52
    v_add_f32 v101, v101, v53
    v_add_f32 v102, v102, v54
    v_add_f32 v103, v103, v55
    v_add_f32 v104, v104, v56
    v_add_f32 v105, v105, v57
    v_add_f32 v106, v106, v58
    v_add_f32 v107, v107, v59
    v_add_f32 v108, v108, v60
    v_add_f32 v109, v109, v61
    v_add_f32 v110, v110, v62
    v_add_f32 v111, v111, v63
K3_AD1:
    s_cmp_eq_u32 s42, 2
    s_cbranch_scc1 K3_AD2
    v_add_f32 v96, v96, v64
    v_add_f32 v97, v97, v65
    v_add_f32 v98, v98, v66
    v_add_f32 v99, v99, v67
    v_add_f32 v100, v100, v68
    v_add_f32 v101, v101, v69
    v_add_f32 v102, v102, v70
    v_add_f32 v103, v103, v71
    v_add_f32 v104, v104, v72
    v_add_f32 v105, v105, v73
    v_add_f32 v106, v106, v74
    v_add_f32 v107, v107, v75
    v_add_f32 v108, v108, v76
    v_add_f32 v109, v109, v77
    v_add_f32 v110, v110, v78
    v_add_f32 v111, v111, v79
K3_AD2:
    s_cmp_eq_u32 s42, 3
    s_cbranch_scc1 K3_AD3
    v_add_f32 v96, v96, v80
    v_add_f32 v97, v97, v81
    v_add_f32 v98, v98, v82
    v_add_f32 v99, v99, v83
    v_add_f32 v100, v100, v84
    v_add_f32 v101, v101, v85
    v_add_f32 v102, v102, v86
    v_add_f32 v103, v103, v87
    v_add_f32 v104, v104, v88
    v_add_f32 v105, v105, v89
    v_add_f32 v106, v106, v90
    v_add_f32 v107, v107, v91
    v_add_f32 v108, v108, v92
    v_add_f32 v109, v109, v93
    v_add_f32 v110, v110, v94
    v_add_f32 v111, v111, v95
K3_AD3:
    v_sub_f32 v96, v96, v8
    v_sub_f32 v97, v97, v9
    v_sub_f32 v98, v98, v10
    v_sub_f32 v99, v99, v11
    v_sub_f32 v100, v100, v12
    v_sub_f32 v101, v101, v13
    v_sub_f32 v102, v102, v14
    v_sub_f32 v103, v103, v15
    v_sub_f32 v104, v104, v16
    v_sub_f32 v105, v105, v17
    v_sub_f32 v106, v106, v18
    v_sub_f32 v107, v107, v19
    v_sub_f32 v108, v108, v20
    v_sub_f32 v109, v109, v21
    v_sub_f32 v110, v110, v22
    v_sub_f32 v111, v111, v23
    v_fma_f32 v96, v6, v96, v8
    v_fma_f32 v97, v6, v97, v9
    v_fma_f32 v98, v6, v98, v10
    v_fma_f32 v99, v6, v99, v11
    v_fma_f32 v100, v6, v100, v12
    v_fma_f32 v101, v6, v101, v13
    v_fma_f32 v102, v6, v102, v14
    v_fma_f32 v103, v6, v103, v15
    v_fma_f32 v104, v6, v104, v16
    v_fma_f32 v105, v6, v105, v17
    v_fma_f32 v106, v6, v106, v18
    v_fma_f32 v107, v6, v107, v19
    v_fma_f32 v108, v6, v108, v20
    v_fma_f32 v109, v6, v109, v21
    v_fma_f32 v110, v6, v110, v22
    v_fma_f32 v111, v6, v111, v23
    v_cvt_pk_bf16_f32 v8, v96, v97
    v_cvt_pk_bf16_f32 v9, v98, v99
    v_cvt_pk_bf16_f32 v10, v100, v101
    v_cvt_pk_bf16_f32 v11, v102, v103
    v_cvt_pk_bf16_f32 v12, v104, v105
    v_cvt_pk_bf16_f32 v13, v106, v107
    v_cvt_pk_bf16_f32 v14, v108, v109
    v_cvt_pk_bf16_f32 v15, v110, v111
    s_nop 1
    v_permlane32_swap_b32 v8, v10
    v_permlane32_swap_b32 v9, v11
    v_permlane32_swap_b32 v12, v14
    v_permlane32_swap_b32 v13, v15
    v_lshlrev_b32 v2, 10, v5
    v_lshrrev_b32 v3, 5, v1
    v_lshl_add_u32 v2, v3, 4, v2
    s_lshl_b32 s44, s41, 7
    s_lshl_b32 s45, s49, 6
    s_add_u32 s44, s44, s45
    buffer_store_dwordx4 v[8:11], v2, s[36:39], s44 offen
    buffer_store_dwordx4 v[12:15], v2, s[36:39], s44 offen offset:32
K3_END:
    s_endpgm
.section .rodata,"a"
.p2align 6
.amdhsa_kernel out_kernel
  .amdhsa_next_free_vgpr 224
  .amdhsa_next_free_sgpr 102
  .amdhsa_accum_offset 224
  .amdhsa_group_segment_fixed_size 0
  .amdhsa_kernarg_size 88
  .amdhsa_user_sgpr_count 2
  .amdhsa_user_sgpr_kernarg_segment_ptr 1
  .amdhsa_system_sgpr_workgroup_id_x 1
.end_amdhsa_kernel
```
